```python
import torch

def _softmax(x, axis=-1):
    return torch.softmax(x, dim=axis)
def _gelu(x):
    return torch.nn.functional.gelu(x, approximate="tanh")
def _silu(x):
    return torch.nn.functional.silu(x)
def _sigmoid(x):
    return torch.sigmoid(x)
def _layernorm(x, axis=-1, eps=1e-5):
    m = x.mean(dim=axis, keepdim=True)
    v = x.var(dim=axis, keepdim=True, unbiased=False)
    return (x - m) / torch.sqrt(v + eps)
def _scatter_add(tgt, idx, src, axis=0):
    return tgt.clone().index_add_(axis, idx, src)
def _segment_sum(src, seg, n):
    out = torch.zeros((n,) + src.shape[1:], dtype=src.dtype)
    return out.index_add_(0, seg, src)
def _pad(x, pw):
    flat = tuple(v for pair in reversed(pw) for v in pair)
    return torch.nn.functional.pad(x, flat)

kernel_name = 'sequential_preLN__linear_attn_block__moe_arch_mod__prompt'

def setup_inputs():

    _w = (lambda a: (lambda t: t.to(torch.bfloat16) if t.is_floating_point() else t)(torch.as_tensor(a)))
    def _A_setup():
        B, S, D = 1, 2048, 576
        return {
            "x": _w((lambda *s: torch.randn(*s, dtype=torch.bfloat16) * 0.05)(B, S, D)),
            "wqkv": _w((lambda *s: torch.randn(*s, dtype=torch.bfloat16) * 0.2)(D, 3 * D)),
            "wo": _w((lambda *s: torch.randn(*s, dtype=torch.bfloat16) * 0.2)(D, D)),
        }
    _A_in = _A_setup()

    def _B_setup():
        B, S, D, F, C = 1, 2048, 576, 4608, 2
        return {
            "x": _w((lambda *s: torch.randn(*s, dtype=torch.bfloat16) * 0.05)(B, S, D)),
            "w_r": _w((lambda *s: torch.randn(*s, dtype=torch.bfloat16) * 0.2)(D)),
            "w_gate": _w((lambda *s: torch.randn(*s, dtype=torch.bfloat16) * 0.2)(D, F)),
            "w_up": _w((lambda *s: torch.randn(*s, dtype=torch.bfloat16) * 0.2)(D, F)),
            "w_down": _w((lambda *s: torch.randn(*s, dtype=torch.bfloat16) * 0.2)(F, D)),
        }
    _B_in = _B_setup()

    return {
        "A_x": _A_in["x"],
        "A_wqkv": _A_in["wqkv"],
        "A_wo": _A_in["wo"],
        "B_x": _B_in["x"],
        "B_w_r": _B_in["w_r"],
        "B_w_gate": _B_in["w_gate"],
        "B_w_up": _B_in["w_up"],
        "B_w_down": _B_in["w_down"],
    }

def reference(A_x, A_wqkv, A_wo, B_x, B_w_r, B_w_gate, B_w_up, B_w_down):
    def _A_ref(x, wqkv, wo):
        B, S, D = x.shape
        H = 32; Dh = D // H
        qkv = (lambda x, *d: x.permute(*d))((x @ wqkv).reshape(B, S, 3, H, Dh), 2, 0, 3, 1, 4)
        q, k, v = qkv[0], qkv[1], qkv[2]
        phi = lambda t: torch.where(t > 0, t + 1, torch.exp(t)) + 1e-6
        pq, pk = phi(q), phi(k)
        kv = torch.einsum("bhsd,bhse->bhde", pk, v)
        z = torch.einsum("bhsd->bhd", pk)
        num = torch.einsum("bhqd,bhde->bhqe", pq, kv)
        den = torch.einsum("bhqd,bhd->bhq", pq, z)[..., None] + 1e-6
        o = num / den
        return (lambda x, *d: x.permute(*d))(o, 0, 2, 1, 3).reshape(B, S, D) @ wo

    def _B_ref(x, w_r, w_gate, w_up, w_down):
        B, S, D = x.shape
        C = 2
        r = x @ w_r
        idx = torch.argsort(-r, axis=-1)[:, :C]
        idx_e = (lambda x, n, axis: torch.repeat_interleave(x, n, dim=axis))(idx.reshape(B, C, 1), D, axis=2)
        x_sel = (lambda x, i, axis: torch.take_along_dim(x, i, dim=axis))(x, idx_e, axis=1)
        g = _silu(x_sel @ w_gate)
        u = x_sel @ w_up
        y = (g * u) @ w_down
        r_sel = _sigmoid((lambda x, i, axis: torch.take_along_dim(x, i, dim=axis))(r, idx, axis=1))
        y = y * r_sel.reshape(B, C, 1)
        b_off = (torch.arange(B) * S).reshape(B, 1)
        flat_idx = (idx + b_off).reshape(B * C)
        zero = (x * 0.0).reshape(B * S, D)
        upd = _scatter_add(zero, flat_idx, y.reshape(B * C, D), axis=0)
        return x + upd.reshape(B, S, D)

    x = A_x
    h = x + _A_ref(_layernorm(x, axis=-1), A_wqkv, A_wo)
    h2 = h + _B_ref(_layernorm(h, axis=-1), B_w_r, B_w_gate, B_w_up, B_w_down)
    return h2
```

```asm
; @launch grid=(256,1,1) block=(512,1,1) lds=163840
.amdgcn_target "amdgcn-amd-amdhsa--gfx950"
.text
.globl sequential_preLN__linear_attn_block__moe_arch_mod__prompt_kernel
.p2align 12
.p2align 8
.type sequential_preLN__linear_attn_block__moe_arch_mod__prompt_kernel,@function
sequential_preLN__linear_attn_block__moe_arch_mod__prompt_kernel:
    s_load_dwordx16 s[16:31], s[0:1], 0
    s_load_dwordx4 s[32:35], s[0:1], 64
    s_load_dwordx2 s[36:37], s[0:1], 80
    s_cmp_ge_u32 s2, 256
    s_cbranch_scc1 L_exit
    v_lshrrev_b32 v1, 6, v0
    v_and_b32 v0, 63, v0
    v_readfirstlane_b32 s3, v1
    s_and_b32 s4, s2, 7
    s_lshr_b32 s5, s2, 3
    v_lshrrev_b32 v3, 4, v0
    v_and_b32 v2, 15, v0
    s_cmp_ge_u32 s5, 24
    s_cbranch_scc0 L_gemm
    s_getpc_b64 s[80:81]
L_pc:
    s_lshl_b32 s14, s3, 13
    v_lshl_add_u32 v7, v0, 7, s14
    v_min_u32 v7, (L_code_end-L_pc-4), v7
    global_load_dword v250, v7, s[80:81]
    s_branch L_helper
L_gemm:
    s_and_b32 s80, s3, 3
    v_lshrrev_b32 v4, 3, v0
    v_and_b32 v5, 7, v0
    v_xor_b32 v5, v5, v3
    s_lshl_b32 s14, s80, 5
    v_add_u32 v4, s14, v4
    v_mul_u32_u24 v4, 1152, v4
    s_and_b32 s14, s5, 3
    s_and_b32 s15, s4, 3
    s_lshr_b32 s10, s4, 2
    s_and_b32 s6, s5, 1
    s_lshl1_add_u32 s6, s10, s6
    s_cmp_lt_u32 s5, 16
    s_cselect_b32 s6, s14, s6
    v_lshl_add_u32 v240, v5, 4, v4
    s_cselect_b32 s84, 1, 5
    s_mov_b32 s85, 0x15723704
    s_cselect_b32 s85, 0x75313186, s85
    s_cmp_lt_u32 s5, 8
    s_cselect_b32 s85, 0x7536420, s85
    s_lshl_b32 s14, s5, 2
    s_lshr_b32 s85, s85, s14
    s_and_b32 s85, s85, 15
    s_mul_i32 s84, s84, s10
    s_lshl1_add_u32 s85, s15, s85
    s_add_u32 s85, s85, s84
    s_sub_u32 s14, s85, 9
    s_cselect_b32 s85, s85, s14
    s_sub_u32 s14, s85, 9
    s_cselect_b32 s85, s85, s14
    v_xor_b32 v241, 64, v240
    s_lshl2_add_u32 s6, s15, s6
    s_mul_i32 s87, s6, 147456
    v_add_u32 v241, 9216, v241
    s_lshl_b32 s81, s80, 12
    v_add_u32 v242, 18432, v240
    s_lshl_b32 s83, s85, 7
    v_add_u32 v243, 18432, v241
    s_add_u32 s83, s83, s87
    s_mov_b32 s42, 2359296
    s_mov_b32 s43, 0x20000
    s_waitcnt lgkmcnt(0)
    s_mov_b32 s40, s16
    s_mov_b32 s41, s17
    s_cmp_ge_u32 s3, 4
    s_cbranch_scc1 L_nox0
    s_add_u32 m0, s81, 0
    s_nop 0
    buffer_load_dwordx4 v240, s[40:43], s83 offen lds
    s_add_u32 m0, s81, 1024
    s_nop 0
    buffer_load_dwordx4 v241, s[40:43], s83 offen lds
    s_add_u32 m0, s81, 2048
    s_nop 0
    buffer_load_dwordx4 v242, s[40:43], s83 offen lds
    s_add_u32 m0, s81, 3072
    s_nop 0
    buffer_load_dwordx4 v243, s[40:43], s83 offen lds
    s_branch L_nox1
L_nox0:
L_nox1:
    s_lshr_b32 s7, s5, 2
    s_lshl2_add_u32 s13, s10, s7
    s_mul_i32 s8, s13, 144
    s_add_u32 s8, s8, 1152
    s_movk_i32 s9, 1152
    s_cmp_lt_u32 s7, 4
    s_cbranch_scc1 L_setup_done
    s_bfe_u32 s13, s5, 0x20001
    s_mul_i32 s8, s13, 288
    s_movk_i32 s9, 144
L_setup_done:
    s_mov_b32 s44, s18
    s_mov_b32 s45, s19
    s_mov_b32 s46, 1990656
    s_mov_b32 s47, 0x20000
    s_lshr_b32 s14, s80, 1
    s_and_b32 s15, s80, 1
    s_lshl3_add_u32 s14, s14, s15
    s_mul_i32 s14, s14, 13824
    s_add_u32 s15, s14, s9
    s_sub_u32 s15, s15, 144
    v_mov_b32 v6, s14
    v_mov_b32 v7, s15
    s_mul_i32 s82, s80, 4608
    s_add_u32 s82, s82, 16384
    s_mul_i32 s84, s85, 221184
    s_add_u32 s84, s84, s8
    s_movk_i32 s14, 3456
    s_movk_i32 s15, -18
    v_add_u32 v4, 0, v0
    v_mul_u32_u24 v5, 911, v4
    v_lshrrev_b32 v5, 14, v5
    v_mad_i32_i24 v4, v5, s15, v4
    v_and_b32 v1, 12, v5
    v_cmp_lt_u32 vcc, 8, v4
    v_add_u32 v5, v5, v1
    v_lshlrev_b32 v4, 4, v4
    v_mad_u32_u24 v5, v5, s14, v4
    v_cndmask_b32 v1, v6, v7, vcc
    v_add_u32 v244, v5, v1
    v_add_u32 v4, 64, v0
    v_mul_u32_u24 v5, 911, v4
    v_lshrrev_b32 v5, 14, v5
    v_mad_i32_i24 v4, v5, s15, v4
    v_and_b32 v1, 12, v5
    v_cmp_lt_u32 vcc, 8, v4
    v_add_u32 v5, v5, v1
    v_lshlrev_b32 v4, 4, v4
    v_mad_u32_u24 v5, v5, s14, v4
    v_cndmask_b32 v1, v6, v7, vcc
    v_add_u32 v245, v5, v1
    v_add_u32 v4, 128, v0
    v_mul_u32_u24 v5, 911, v4
    v_lshrrev_b32 v5, 14, v5
    v_mad_i32_i24 v4, v5, s15, v4
    v_and_b32 v1, 12, v5
    v_cmp_lt_u32 vcc, 8, v4
    v_add_u32 v5, v5, v1
    v_lshlrev_b32 v4, 4, v4
    v_mad_u32_u24 v5, v5, s14, v4
    v_cndmask_b32 v1, v6, v7, vcc
    v_add_u32 v246, v5, v1
    v_add_u32 v4, 192, v0
    v_mul_u32_u24 v5, 911, v4
    v_lshrrev_b32 v5, 14, v5
    v_mad_i32_i24 v4, v5, s15, v4
    v_and_b32 v1, 12, v5
    v_cmp_lt_u32 vcc, 8, v4
    v_add_u32 v5, v5, v1
    v_lshlrev_b32 v4, 4, v4
    v_mad_u32_u24 v5, v5, s14, v4
    v_cndmask_b32 v1, v6, v7, vcc
    v_add_u32 v247, v5, v1
    v_add_u32 v4, 256, v0
    v_mul_u32_u24 v5, 911, v4
    v_lshrrev_b32 v5, 14, v5
    v_mad_i32_i24 v4, v5, s15, v4
    v_and_b32 v1, 12, v5
    v_cmp_lt_u32 vcc, 8, v4
    v_add_u32 v5, v5, v1
    v_lshlrev_b32 v4, 4, v4
    v_mad_u32_u24 v5, v5, s14, v4
    v_cndmask_b32 v1, v6, v7, vcc
    v_add_u32 v248, v5, v1
    v_mov_b32 v252, 163200
    v_mov_b32 v253, 1
    s_cmp_ge_u32 s3, 4
    s_cbranch_scc1 L_loader
    s_add_u32 m0, s82, 0
    s_nop 0
    buffer_load_dwordx4 v244, s[44:47], s84 offen lds
    s_add_u32 m0, s82, 1024
    s_nop 0
    buffer_load_dwordx4 v245, s[44:47], s84 offen lds
    s_add_u32 m0, s82, 2048
    s_nop 0
    buffer_load_dwordx4 v246, s[44:47], s84 offen lds
    s_add_u32 m0, s82, 3072
    s_nop 0
    buffer_load_dwordx4 v247, s[44:47], s84 offen lds
    s_add_u32 m0, s82, 4096
    s_mov_b32 exec_hi, 0
    buffer_load_dwordx4 v248, s[44:47], s84 offen lds
    s_mov_b32 exec_hi, -1
    s_branch L_compute
L_loader:
    s_add_u32 s85, s85, 1
    s_cmp_eq_u32 s85, 9
    s_cselect_b32 s85, 0, s85
    s_lshl_b32 s83, s85, 7
    s_add_u32 s83, s83, s87
    s_mul_i32 s84, s85, 221184
    s_add_u32 s84, s84, s8
    s_mul_i32 s11, s5, 43
    s_lshr_b32 s11, s11, 8
    s_mul_i32 s12, s11, 6
    s_sub_u32 s12, s5, s12
    s_and_b32 s15, s4, 3
    s_lshl3_add_u32 s11, s15, s11
    s_lshl2_add_u32 s11, s10, s11
    s_mov_b32 s48, s36
    s_mov_b32 s49, s37
    s_mov_b32 s50, 4526080
    s_mov_b32 s51, 0x20000
    s_mov_b32 s56, s20
    s_mov_b32 s57, s21
    s_mov_b32 s58, 663552
    s_mov_b32 s59, 0x20000
    s_mov_b32 s64, s24
    s_mov_b32 s65, s25
    s_mov_b32 s66, 1152
    s_mov_b32 s67, 0x20000
    s_mov_b32 s60, s32
    s_mov_b32 s61, s33
    s_mov_b32 s62, 2359296
    s_mov_b32 s63, 0x20000
    v_lshlrev_b32 v11, 4, v0
    v_mov_b32 v4, 0
    v_lshl_add_u32 v5, v2, 2, v252
    ds_write_b32 v5, v4
    s_mul_i32 s86, s80, 9216
    s_lshl1_add_u32 s75, s5, s80
    s_and_b32 s75, s75, 31
    s_lshr_b32 s14, s75, 2
    s_lshl3_add_u32 s14, s4, s14
    s_lshl_b32 s14, s14, 5
    s_and_b32 s15, s75, 3
    s_add_u32 s14, s14, s15
    s_lshl_b32 s14, s14, 2
    s_add_u32 s78, s14, 3489792
    s_lshl3_add_u32 s75, s75, s4
    s_lshr_b32 s14, s80, 1
    s_lshr_b32 s15, s5, 4
    s_or_b32 s92, s14, s15
    s_mul_i32 s88, s12, 192
    s_movk_i32 s90, 1152
    v_add_u32 v4, 0, v0
    v_mul_u32_u24 v5, 683, v4
    v_lshrrev_b32 v5, 13, v5
    v_mad_i32_i24 v4, v5, -12, v4
    v_lshlrev_b32 v4, 4, v4
    v_mad_u32_u24 v128, v5, s90, v4
    v_and_b32 v6, 4, v5
    v_lshlrev_b32 v7, 3, v6
    v_xor_b32 v4, v4, v7
    v_mul_u32_u24 v6, 2592, v6
    v_add_u32 v20, v4, v6
    v_and_b32 v24, 11, v5
    v_add_u32 v4, 64, v0
    v_mul_u32_u24 v5, 683, v4
    v_lshrrev_b32 v5, 13, v5
    v_mad_i32_i24 v4, v5, -12, v4
    v_lshlrev_b32 v4, 4, v4
    v_mad_u32_u24 v129, v5, s90, v4
    v_and_b32 v6, 4, v5
    v_lshlrev_b32 v7, 3, v6
    v_xor_b32 v4, v4, v7
    v_mul_u32_u24 v6, 2592, v6
    v_add_u32 v21, v4, v6
    v_and_b32 v25, 11, v5
    v_add_u32 v4, 128, v0
    v_mul_u32_u24 v5, 683, v4
    v_lshrrev_b32 v5, 13, v5
    v_mad_i32_i24 v4, v5, -12, v4
    v_lshlrev_b32 v4, 4, v4
    v_mad_u32_u24 v130, v5, s90, v4
    v_and_b32 v6, 4, v5
    v_lshlrev_b32 v7, 3, v6
    v_xor_b32 v4, v4, v7
    v_mul_u32_u24 v6, 2592, v6
    v_add_u32 v22, v4, v6
    v_and_b32 v26, 11, v5
    s_mul_i32 s14, s80, 3
    s_add_u32 s14, s14, 0
    s_and_b32 s15, s14, 1
    s_lshl_b32 s14, s14, 3
    s_lshl_b32 s15, s15, 2
    s_sub_u32 s14, s14, s15
    v_add_u32 v5, s14, v24
    v_mul_u32_u24 v1, 911, v5
    v_lshrrev_b32 v1, 13, v1
    v_mad_u32_u24 v1, v1, 9, v5
    v_mad_u32_u24 v100, v1, s90, v20
    v_add_u32 v5, s14, v25
    v_mul_u32_u24 v1, 911, v5
    v_lshrrev_b32 v1, 13, v1
    v_mad_u32_u24 v1, v1, 9, v5
    v_mad_u32_u24 v101, v1, s90, v21
    v_add_u32 v5, s14, v26
    v_mul_u32_u24 v1, 911, v5
    v_lshrrev_b32 v1, 13, v1
    v_mad_u32_u24 v1, v1, 9, v5
    v_mad_u32_u24 v102, v1, s90, v22
    s_mul_i32 s14, s80, 3
    s_add_u32 s14, s14, 1
    s_and_b32 s15, s14, 1
    s_lshl_b32 s14, s14, 3
    s_lshl_b32 s15, s15, 2
    s_sub_u32 s14, s14, s15
    v_add_u32 v5, s14, v24
    v_mul_u32_u24 v1, 911, v5
    v_lshrrev_b32 v1, 13, v1
    v_mad_u32_u24 v1, v1, 9, v5
    v_mad_u32_u24 v103, v1, s90, v20
    v_add_u32 v5, s14, v25
    v_mul_u32_u24 v1, 911, v5
    v_lshrrev_b32 v1, 13, v1
    v_mad_u32_u24 v1, v1, 9, v5
    v_mad_u32_u24 v104, v1, s90, v21
    v_add_u32 v5, s14, v26
    v_mul_u32_u24 v1, 911, v5
    v_lshrrev_b32 v1, 13, v1
    v_mad_u32_u24 v1, v1, 9, v5
    v_mad_u32_u24 v105, v1, s90, v22
    s_mul_i32 s14, s80, 3
    s_add_u32 s14, s14, 2
    s_and_b32 s15, s14, 1
    s_lshl_b32 s14, s14, 3
    s_lshl_b32 s15, s15, 2
    s_sub_u32 s14, s14, s15
    v_add_u32 v5, s14, v24
    v_mul_u32_u24 v1, 911, v5
    v_lshrrev_b32 v1, 13, v1
    v_mad_u32_u24 v1, v1, 9, v5
    v_mad_u32_u24 v106, v1, s90, v20
    v_add_u32 v5, s14, v25
    v_mul_u32_u24 v1, 911, v5
    v_lshrrev_b32 v1, 13, v1
    v_mad_u32_u24 v1, v1, 9, v5
    v_mad_u32_u24 v107, v1, s90, v21
    v_add_u32 v5, s14, v26
    v_mul_u32_u24 v1, 911, v5
    v_lshrrev_b32 v1, 13, v1
    v_mad_u32_u24 v1, v1, 9, v5
    v_mad_u32_u24 v108, v1, s90, v22
    s_mul_i32 s14, s80, 3
    s_add_u32 s14, s14, 12
    s_and_b32 s15, s14, 1
    s_lshl_b32 s14, s14, 3
    s_lshl_b32 s15, s15, 2
    s_sub_u32 s14, s14, s15
    v_add_u32 v5, s14, v24
    v_mul_u32_u24 v1, 911, v5
    v_lshrrev_b32 v1, 13, v1
    v_mad_u32_u24 v1, v1, 9, v5
    v_mad_u32_u24 v109, v1, s90, v20
    v_add_u32 v5, s14, v25
    v_mul_u32_u24 v1, 911, v5
    v_lshrrev_b32 v1, 13, v1
    v_mad_u32_u24 v1, v1, 9, v5
    v_mad_u32_u24 v110, v1, s90, v21
    v_add_u32 v5, s14, v26
    v_mul_u32_u24 v1, 911, v5
    v_lshrrev_b32 v1, 13, v1
    v_mad_u32_u24 v1, v1, 9, v5
    v_mad_u32_u24 v111, v1, s90, v22
    s_mul_i32 s14, s80, 3
    s_add_u32 s14, s14, 13
    s_and_b32 s15, s14, 1
    s_lshl_b32 s14, s14, 3
    s_lshl_b32 s15, s15, 2
    s_sub_u32 s14, s14, s15
    v_add_u32 v5, s14, v24
    v_mul_u32_u24 v1, 911, v5
    v_lshrrev_b32 v1, 13, v1
    v_mad_u32_u24 v1, v1, 9, v5
    v_mad_u32_u24 v112, v1, s90, v20
    v_add_u32 v5, s14, v25
    v_mul_u32_u24 v1, 911, v5
    v_lshrrev_b32 v1, 13, v1
    v_mad_u32_u24 v1, v1, 9, v5
    v_mad_u32_u24 v113, v1, s90, v21
    v_add_u32 v5, s14, v26
    v_mul_u32_u24 v1, 911, v5
    v_lshrrev_b32 v1, 13, v1
    v_mad_u32_u24 v1, v1, 9, v5
    v_mad_u32_u24 v114, v1, s90, v22
    s_mul_i32 s14, s80, 3
    s_add_u32 s14, s14, 14
    s_and_b32 s15, s14, 1
    s_lshl_b32 s14, s14, 3
    s_lshl_b32 s15, s15, 2
    s_sub_u32 s14, s14, s15
    v_add_u32 v5, s14, v24
    v_mul_u32_u24 v1, 911, v5
    v_lshrrev_b32 v1, 13, v1
    v_mad_u32_u24 v1, v1, 9, v5
    v_mad_u32_u24 v115, v1, s90, v20
    v_add_u32 v5, s14, v25
    v_mul_u32_u24 v1, 911, v5
    v_lshrrev_b32 v1, 13, v1
    v_mad_u32_u24 v1, v1, 9, v5
    v_mad_u32_u24 v116, v1, s90, v21
    v_add_u32 v5, s14, v26
    v_mul_u32_u24 v1, 911, v5
    v_lshrrev_b32 v1, 13, v1
    v_mad_u32_u24 v1, v1, 9, v5
    v_mad_u32_u24 v117, v1, s90, v22
    s_mul_i32 s14, s80, 3
    s_add_u32 s14, s14, 24
    s_and_b32 s15, s14, 1
    s_lshl_b32 s14, s14, 3
    s_lshl_b32 s15, s15, 2
    s_sub_u32 s14, s14, s15
    v_add_u32 v5, s14, v24
    v_mul_u32_u24 v1, 911, v5
    v_lshrrev_b32 v1, 13, v1
    v_mad_u32_u24 v1, v1, 9, v5
    v_mad_u32_u24 v118, v1, s90, v20
    v_add_u32 v5, s14, v25
    v_mul_u32_u24 v1, 911, v5
    v_lshrrev_b32 v1, 13, v1
    v_mad_u32_u24 v1, v1, 9, v5
    v_mad_u32_u24 v119, v1, s90, v21
    v_add_u32 v5, s14, v26
    v_mul_u32_u24 v1, 911, v5
    v_lshrrev_b32 v1, 13, v1
    v_mad_u32_u24 v1, v1, 9, v5
    v_mad_u32_u24 v120, v1, s90, v22
    s_mul_i32 s14, s80, 3
    s_add_u32 s14, s14, 25
    s_and_b32 s15, s14, 1
    s_lshl_b32 s14, s14, 3
    s_lshl_b32 s15, s15, 2
    s_sub_u32 s14, s14, s15
    v_add_u32 v5, s14, v24
    v_mul_u32_u24 v1, 911, v5
    v_lshrrev_b32 v1, 13, v1
    v_mad_u32_u24 v1, v1, 9, v5
    v_mad_u32_u24 v121, v1, s90, v20
    v_add_u32 v5, s14, v25
    v_mul_u32_u24 v1, 911, v5
    v_lshrrev_b32 v1, 13, v1
    v_mad_u32_u24 v1, v1, 9, v5
    v_mad_u32_u24 v122, v1, s90, v21
    v_add_u32 v5, s14, v26
    v_mul_u32_u24 v1, 911, v5
    v_lshrrev_b32 v1, 13, v1
    v_mad_u32_u24 v1, v1, 9, v5
    v_mad_u32_u24 v123, v1, s90, v22
    s_mul_i32 s14, s80, 3
    s_add_u32 s14, s14, 26
    s_and_b32 s15, s14, 1
    s_lshl_b32 s14, s14, 3
    s_lshl_b32 s15, s15, 2
    s_sub_u32 s14, s14, s15
    v_add_u32 v5, s14, v24
    v_mul_u32_u24 v1, 911, v5
    v_lshrrev_b32 v1, 13, v1
    v_mad_u32_u24 v1, v1, 9, v5
    v_mad_u32_u24 v124, v1, s90, v20
    v_add_u32 v5, s14, v25
    v_mul_u32_u24 v1, 911, v5
    v_lshrrev_b32 v1, 13, v1
    v_mad_u32_u24 v1, v1, 9, v5
    v_mad_u32_u24 v125, v1, s90, v21
    v_add_u32 v5, s14, v26
    v_mul_u32_u24 v1, 911, v5
    v_lshrrev_b32 v1, 13, v1
    v_mad_u32_u24 v1, v1, 9, v5
    v_mad_u32_u24 v126, v1, s90, v22
    v_lshrrev_b32 v4, 2, v0
    v_and_b32 v5, 3, v0
    s_and_b32 s14, s3, 1
    s_mul_i32 s14, s14, 96
    v_mad_u32_u24 v5, v5, 24, s14
    v_and_b32 v6, 4, v4
    v_lshlrev_b32 v6, 3, v6
    s_lshr_b32 s14, s3, 2
    s_mul_i32 s14, s14, 55296
    s_add_u32 s14, s14, 36864
    v_mul_u32_u24 v4, 192, v4
    v_add_u32 v4, s14, v4
    v_add_u32 v7, 0, v5
    v_xor_b32 v7, v7, v6
    v_add_u32 v8, v7, v4
    v_add_u32 v7, 8, v5
    v_xor_b32 v7, v7, v6
    v_add_u32 v9, v7, v4
    v_add_u32 v7, 16, v5
    v_xor_b32 v7, v7, v6
    v_add_u32 v10, v7, v4
    s_lshr_b32 s14, s80, 1
    s_mul_i32 s14, s14, s9
    s_add_u32 s14, s14, s8
    s_lshr_b32 s14, s14, 1
    s_sub_u32 s14, s14, 64
    v_lshl_add_u32 v4, v0, 2, s14
    v_lshrrev_b32 v5, 6, v4
    v_and_b32 v4, 63, v4
    v_lshlrev_b32 v4, 2, v4
    v_lshl_add_u32 v4, v5, 10, v4
    s_and_b32 s15, s80, 1
    s_lshl_b32 s15, s15, 9
    s_add_u32 s15, s15, 256
    v_add_u32 v4, s15, v4
    s_lshl2_add_u32 s15, s6, s80
    s_lshl_b32 s15, s15, 9
    v_add_u32 v5, s15, v11
    v_cmp_gt_u32 vcc, 16, v0
    s_mov_b32 s90, 3497984
    s_mul_i32 s91, s80, 544
    v_cndmask_b32 v131, v4, v5, vcc
    s_add_u32 s91, s91, 159744
    v_add_u32 v132, s91, v11
    s_lshr_b32 s15, s75, 3
    s_and_b32 s72, s75, 7
    s_lshl_b32 s73, s75, 7
    s_add_u32 s73, s73, 3407872
    s_lshl_b32 s15, s15, 15
    s_lshl_b32 s14, s72, 8
    s_add_u32 s74, s15, s14
    s_add_u32 s74, s74, 2359296
    v_and_b32 v4, 1, v0
    v_lshrrev_b32 v5, 1, v2
    v_lshlrev_b32 v7, 4, v5
    v_lshl_add_u32 v7, v4, 7, v7
    v_and_b32 v6, 3, v5
    v_lshlrev_b32 v6, 4, v6
    v_lshl_add_u32 v6, v4, 6, v6
    v_lshrrev_b32 v5, 2, v5
    v_lshl_add_u32 v6, v5, 7, v6
    s_cmp_ge_u32 s72, 6
    s_cselect_b64 s[76:77], -1, 0
    v_cndmask_b32 v7, v7, v6, s[76:77]
    v_lshl_add_u32 v40, v3, 11, v7
    v_add_u32 v41, 8192, v40
    v_add_u32 v42, 16384, v40
    v_add_u32 v43, 24576, v40
    v_lshlrev_b32 v44, 3, v0
    s_cmp_eq_u32 s72, 7
    s_cselect_b32 s76, 0x00ff00ff, -1
    s_mov_b32 s77, s76
    s_and_b32 s16, s3, 1
    s_lshr_b32 s17, s3, 2
    s_bfe_u32 s39, s3, 0x10001
    s_lshl1_add_u32 s18, s11, s39
    s_lshl1_add_u32 s18, s18, s17
    v_mov_b32 v60, 0
    v_mov_b32 v61, 0
    v_mov_b32 v62, 0
    v_mov_b32 v63, 0
    v_mov_b32 v64, 0
    v_mov_b32 v65, 0
    v_mov_b32 v66, 0
    v_mov_b32 v67, 0
    v_mov_b32 v68, 0
    v_mov_b32 v69, 0
    v_mov_b32 v70, 0
    v_mov_b32 v71, 0
    v_mov_b32 v72, 0
    v_mov_b32 v73, 0
    v_mov_b32 v74, 0
    v_mov_b32 v75, 0
    v_mov_b32 v76, 0
    v_mov_b32 v77, 0
    v_mov_b32 v78, 0
    v_mov_b32 v79, 0
    v_mov_b32 v80, 0
    v_mov_b32 v81, 0
    v_mov_b32 v82, 0
    v_mov_b32 v83, 0
    v_mov_b32 v84, 0
    v_mov_b32 v85, 0
    v_mov_b32 v86, 0
    v_mov_b32 v87, 0
    v_mov_b32 v88, 0
    v_mov_b32 v89, 0
    v_mov_b32 v90, 0
    v_mov_b32 v91, 0
    v_and_b32 v4, 31, v0
    v_lshrrev_b32 v5, 3, v4
    v_and_b32 v6, 3, v0
    v_lshl_add_u32 v5, v5, 2, v6
    v_bfe_u32 v6, v0, 2, 1
    v_mad_u32_u24 v6, v6, 9, v5
    v_cmp_gt_u32 vcc, 9, v5
    v_lshrrev_b32 v7, 5, v0
    s_nop 0
    v_cndmask_b32 v6, 18, v6, vcc
    v_subrev_u32 v7, s16, v7
    v_cmp_gt_u32 vcc, 16, v6
    v_mov_b32 v4, 64
    v_mov_b32 v5, 256
    v_cndmask_b32 v4, v4, v5, vcc
    v_mov_b32 v5, 512
    v_cndmask_b32 v5, v5, 0, vcc
    v_lshl_add_u32 v6, v6, 4, v5
    s_lshl_b32 s20, s3, 12
    s_add_u32 s20, s20, 110592
    v_add_u32 v6, s20, v6
    v_mad_i32_i24 v12, v7, v4, v6
    v_lshl_add_u32 v139, v4, 1, v12
    s_lshl_b32 s23, s3, 12
    s_add_u32 s23, s23, 3407872
    s_cmp_eq_u32 s16, 0
    s_mov_b32 s14, 0x33ffff
    s_cselect_b32 s24, s14, 0
    s_mov_b32 s25, s14
    s_mov_b32 s26, s14
    s_cselect_b32 s27, 0, s14
    s_mul_i32 s14, s3, 72
    v_mul_u32_u24 v13, 592, v0
    v_add_u32 v13, s14, v13
    v_and_b32 v4, 1, v3
    v_lshl_add_u32 v4, v4, 5, v2
    v_mul_u32_u24 v4, 592, v4
    v_lshrrev_b32 v5, 1, v3
    v_lshl_add_u32 v4, v5, 4, v4
    s_mul_i32 s15, s39, 37888
    s_mul_i32 s14, s17, 9760
    s_add_u32 s14, s14, s15
    v_add_u32 v14, s14, v4
    s_mul_i32 s14, s17, -9184
    s_add_u32 s14, s14, s15
    s_add_u32 s14, s14, 9472
    v_add_u32 v15, s14, v4
    s_and_b32 s14, s18, 3
    s_mul_i32 s14, s14, 3072
    s_mul_i32 s15, s16, 96
    s_add_u32 s14, s14, s15
    s_add_u32 s14, s14, 147456
    v_mul_u32_u24 v4, 192, v2
    v_mad_u32_u24 v5, v3, 24, v4
    v_add_u32 v16, s14, v5
    s_add_u32 s15, s15, 162816
    v_mad_u32_u24 v136, v3, 24, s15
    v_lshlrev_b32 v4, 4, v2
    v_and_b32 v6, 7, v0
    v_lshlrev_b32 v6, 4, v6
    v_bfe_u32 v7, v0, 3, 1
    v_mul_u32_u24 v7, 1152, v7
    v_add_u32 v17, v6, v7
    v_mul_u32_u24 v5, 768, v3
    v_add_u32 v143, v5, v4
    s_lshl_b32 s14, s18, 4
    s_sub_u32 s14, 0xfff, s14
    v_sub_u32 v18, s14, v2
    s_mul_i32 s15, s3, 3072
    s_add_u32 s15, s15, 77824
    v_add_u32 v19, s15, v11
    s_xor_b32 s14, s3, 4
    s_mul_i32 s15, s14, 3072
    s_add_u32 s15, s15, 77824
    v_add_u32 v138, s15, v11
    s_mov_b32 s94, s15
    s_getreg_b32 s95, hwreg(HW_REG_XCC_ID)
    s_and_b32 s95, s95, 7
    s_or_b32 s95, s95, 8
    s_mul_i32 s28, s18, 3072
    s_add_u32 s28, s28, 3538944
    s_lshl1_add_u32 s31, s12, s16
    s_lshl_b32 s29, s31, 8
    s_add_u32 s29, s29, s28
    s_mul_i32 s30, s31, 96
    s_mul_i32 s15, s18, 2304
    s_add_u32 s30, s30, s15
    s_add_u32 s30, s30, 3932160
    s_and_b32 s14, s18, 3
    s_lshl_b32 s14, s14, 1
    s_xor_b32 s79, s31, s14
    s_lshr_b32 s14, s3, 1
    s_lshl3_add_u32 s14, s11, s14
    s_lshl_b32 s14, s14, 7
    v_lshl_add_u32 v4, v0, 9, s14
    s_lshl3_add_u32 s14, s4, s3
    s_lshl_b32 s14, s14, 7
    s_add_u32 s14, s14, 49144
    v_lshl_add_u32 v5, v0, 2, s14
    v_cmp_gt_u32 vcc, 2, v0
    s_mov_b32 s19, 3440640
    s_nop 0
    v_cndmask_b32 v140, v5, v4, vcc
    s_mul_i32 s21, s11, 73728
    s_mul_i32 s14, s3, 9
    s_lshr_b32 s14, s14, 1
    s_lshl_b32 s14, s14, 10
    s_add_u32 s21, s21, s14
    s_add_u32 s21, s21, 0
    s_waitcnt lgkmcnt(0)
    s_barrier
    s_add_u32 s85, s85, 1
    s_cmp_eq_u32 s85, 9
    s_cselect_b32 s85, 0, s85
    s_lshl_b32 s83, s85, 7
    s_add_u32 s83, s83, s87
    s_mul_i32 s84, s85, 221184
    s_add_u32 s84, s84, s8
    s_add_u32 m0, s81, 73728
    s_nop 0
    buffer_load_dwordx4 v240, s[40:43], s83 offen lds
    s_add_u32 m0, s82, 73728
    s_nop 0
    buffer_load_dwordx4 v244, s[44:47], s84 offen lds
    s_add_u32 m0, s81, 74752
    s_nop 0
    buffer_load_dwordx4 v241, s[40:43], s83 offen lds
    s_add_u32 m0, s82, 74752
    s_nop 0
    buffer_load_dwordx4 v245, s[44:47], s84 offen lds
    s_add_u32 m0, s81, 75776
    s_nop 0
    buffer_load_dwordx4 v242, s[40:43], s83 offen lds
    s_add_u32 m0, s82, 75776
    s_nop 0
    buffer_load_dwordx4 v246, s[44:47], s84 offen lds
    s_add_u32 m0, s81, 76800
    s_nop 0
    buffer_load_dwordx4 v243, s[40:43], s83 offen lds
    s_add_u32 m0, s82, 76800
    s_nop 0
    buffer_load_dwordx4 v247, s[44:47], s84 offen lds
    s_add_u32 m0, s82, 77824
    s_mov_b32 exec_hi, 0
    buffer_load_dwordx4 v248, s[44:47], s84 offen lds
    s_mov_b32 exec_hi, -1
    s_barrier
    s_add_u32 s85, s85, 1
    s_cmp_eq_u32 s85, 9
    s_cselect_b32 s85, 0, s85
    s_lshl_b32 s83, s85, 7
    s_add_u32 s83, s83, s87
    s_mul_i32 s84, s85, 221184
    s_add_u32 s84, s84, s8
    s_add_u32 m0, s81, 110592
    s_nop 0
    buffer_load_dwordx4 v240, s[40:43], s83 offen lds
    s_add_u32 m0, s82, 110592
    s_nop 0
    buffer_load_dwordx4 v244, s[44:47], s84 offen lds
    s_add_u32 m0, s81, 111616
    s_nop 0
    buffer_load_dwordx4 v241, s[40:43], s83 offen lds
    s_add_u32 m0, s82, 111616
    s_nop 0
    buffer_load_dwordx4 v245, s[44:47], s84 offen lds
    s_add_u32 m0, s81, 112640
    s_nop 0
    buffer_load_dwordx4 v242, s[40:43], s83 offen lds
    s_add_u32 m0, s82, 112640
    s_nop 0
    buffer_load_dwordx4 v246, s[44:47], s84 offen lds
    s_add_u32 m0, s81, 113664
    s_nop 0
    buffer_load_dwordx4 v243, s[40:43], s83 offen lds
    s_add_u32 m0, s82, 113664
    s_nop 0
    buffer_load_dwordx4 v247, s[44:47], s84 offen lds
    s_add_u32 m0, s82, 114688
    s_mov_b32 exec_hi, 0
    buffer_load_dwordx4 v248, s[44:47], s84 offen lds
    s_mov_b32 exec_hi, -1
    s_waitcnt vmcnt(9)
    s_barrier
    s_add_u32 s85, s85, 1
    s_cmp_eq_u32 s85, 9
    s_cselect_b32 s85, 0, s85
    s_lshl_b32 s83, s85, 7
    s_add_u32 s83, s83, s87
    s_mul_i32 s84, s85, 221184
    s_add_u32 s84, s84, s8
    s_add_u32 m0, s81, 0
    s_nop 0
    buffer_load_dwordx4 v240, s[40:43], s83 offen lds
    s_add_u32 m0, s82, 0
    s_nop 0
    buffer_load_dwordx4 v244, s[44:47], s84 offen lds
    s_add_u32 m0, s81, 1024
    s_nop 0
    buffer_load_dwordx4 v241, s[40:43], s83 offen lds
    s_add_u32 m0, s82, 1024
    s_nop 0
    buffer_load_dwordx4 v245, s[44:47], s84 offen lds
    s_add_u32 m0, s81, 2048
    s_nop 0
    buffer_load_dwordx4 v242, s[40:43], s83 offen lds
    s_add_u32 m0, s82, 2048
    s_nop 0
    buffer_load_dwordx4 v246, s[44:47], s84 offen lds
    s_add_u32 m0, s81, 3072
    s_nop 0
    buffer_load_dwordx4 v243, s[40:43], s83 offen lds
    s_add_u32 m0, s82, 3072
    s_nop 0
    buffer_load_dwordx4 v247, s[44:47], s84 offen lds
    s_add_u32 m0, s82, 4096
    s_mov_b32 exec_hi, 0
    buffer_load_dwordx4 v248, s[44:47], s84 offen lds
    s_mov_b32 exec_hi, -1
    s_waitcnt vmcnt(9)
    s_barrier
    s_add_u32 s85, s85, 1
    s_cmp_eq_u32 s85, 9
    s_cselect_b32 s85, 0, s85
    s_lshl_b32 s83, s85, 7
    s_add_u32 s83, s83, s87
    s_mul_i32 s84, s85, 221184
    s_add_u32 s84, s84, s8
    s_add_u32 m0, s81, 36864
    s_nop 0
    buffer_load_dwordx4 v240, s[40:43], s83 offen lds
    s_add_u32 m0, s82, 36864
    s_nop 0
    buffer_load_dwordx4 v244, s[44:47], s84 offen lds
    s_add_u32 m0, s81, 37888
    s_nop 0
    buffer_load_dwordx4 v241, s[40:43], s83 offen lds
    s_add_u32 m0, s82, 37888
    s_nop 0
    buffer_load_dwordx4 v245, s[44:47], s84 offen lds
    s_add_u32 m0, s81, 38912
    s_nop 0
    buffer_load_dwordx4 v242, s[40:43], s83 offen lds
    s_add_u32 m0, s82, 38912
    s_nop 0
    buffer_load_dwordx4 v246, s[44:47], s84 offen lds
    s_add_u32 m0, s81, 39936
    s_nop 0
    buffer_load_dwordx4 v243, s[40:43], s83 offen lds
    s_add_u32 m0, s82, 39936
    s_nop 0
    buffer_load_dwordx4 v247, s[44:47], s84 offen lds
    s_add_u32 m0, s82, 40960
    s_mov_b32 exec_hi, 0
    buffer_load_dwordx4 v248, s[44:47], s84 offen lds
    s_mov_b32 exec_hi, -1
    s_waitcnt vmcnt(9)
    s_barrier
    s_add_u32 s85, s85, 1
    s_cmp_eq_u32 s85, 9
    s_cselect_b32 s85, 0, s85
    s_lshl_b32 s83, s85, 7
    s_add_u32 s83, s83, s87
    s_mul_i32 s84, s85, 221184
    s_add_u32 s84, s84, s8
    s_add_u32 m0, s81, 73728
    s_nop 0
    buffer_load_dwordx4 v240, s[40:43], s83 offen lds
    s_add_u32 m0, s82, 73728
    s_nop 0
    buffer_load_dwordx4 v244, s[44:47], s84 offen lds
    s_add_u32 m0, s81, 74752
    s_nop 0
    buffer_load_dwordx4 v241, s[40:43], s83 offen lds
    s_add_u32 m0, s82, 74752
    s_nop 0
    buffer_load_dwordx4 v245, s[44:47], s84 offen lds
    s_add_u32 m0, s81, 75776
    s_nop 0
    buffer_load_dwordx4 v242, s[40:43], s83 offen lds
    s_add_u32 m0, s82, 75776
    s_nop 0
    buffer_load_dwordx4 v246, s[44:47], s84 offen lds
    s_add_u32 m0, s81, 76800
    s_nop 0
    buffer_load_dwordx4 v243, s[40:43], s83 offen lds
    s_add_u32 m0, s82, 76800
    s_nop 0
    buffer_load_dwordx4 v247, s[44:47], s84 offen lds
    s_add_u32 m0, s82, 77824
    s_mov_b32 exec_hi, 0
    buffer_load_dwordx4 v248, s[44:47], s84 offen lds
    s_mov_b32 exec_hi, -1
    s_waitcnt vmcnt(9)
    s_barrier
    s_add_u32 s85, s85, 1
    s_cmp_eq_u32 s85, 9
    s_cselect_b32 s85, 0, s85
    s_lshl_b32 s83, s85, 7
    s_add_u32 s83, s83, s87
    s_mul_i32 s84, s85, 221184
    s_add_u32 s84, s84, s8
    s_load_dword s93, s[34:35], 0
    s_add_u32 m0, s81, 110592
    s_nop 0
    buffer_load_dwordx4 v240, s[40:43], s83 offen lds
    s_add_u32 m0, s82, 110592
    s_nop 0
    buffer_load_dwordx4 v244, s[44:47], s84 offen lds
    s_add_u32 m0, s81, 111616
    s_nop 0
    buffer_load_dwordx4 v241, s[40:43], s83 offen lds
    s_add_u32 m0, s82, 111616
    s_nop 0
    buffer_load_dwordx4 v245, s[44:47], s84 offen lds
    s_add_u32 m0, s81, 112640
    s_nop 0
    buffer_load_dwordx4 v242, s[40:43], s83 offen lds
    s_add_u32 m0, s82, 112640
    s_nop 0
    buffer_load_dwordx4 v246, s[44:47], s84 offen lds
    s_add_u32 m0, s81, 113664
    s_nop 0
    buffer_load_dwordx4 v243, s[40:43], s83 offen lds
    s_add_u32 m0, s82, 113664
    s_nop 0
    buffer_load_dwordx4 v247, s[44:47], s84 offen lds
    s_add_u32 m0, s82, 114688
    s_mov_b32 exec_hi, 0
    buffer_load_dwordx4 v248, s[44:47], s84 offen lds
    s_mov_b32 exec_hi, -1
    s_waitcnt vmcnt(9)
    s_barrier
    s_add_u32 s85, s85, 1
    s_cmp_eq_u32 s85, 9
    s_cselect_b32 s85, 0, s85
    s_lshl_b32 s83, s85, 7
    s_add_u32 s83, s83, s87
    s_mul_i32 s84, s85, 221184
    s_add_u32 s84, s84, s8
    s_waitcnt lgkmcnt(0)
    s_cmp_ge_u32 s93, 64
    s_cbranch_scc1 L_ld_flag_ok
    s_mov_b32 s38, 400000
    s_mov_b32 s52, s34
    s_mov_b32 s53, s35
    s_mov_b32 s54, 256
    s_mov_b32 s55, 0x20000
    v_mov_b32 v4, 0
L_ld_flag:
    buffer_load_dword v5, v4, s[52:55], 0 offen sc1
    s_waitcnt vmcnt(0)
    v_cmp_gt_u32 vcc, 64, v5
    s_cbranch_vccz L_ld_flag_ok
    s_sleep 24
    s_sub_u32 s38, s38, 1
    s_cbranch_scc0 L_ld_flag
L_ld_flag_ok:
    s_mov_b32 m0, s91
    s_mov_b32 exec_hi, 3
    buffer_load_dwordx4 v131, s[48:51], s90 offen sc1 lds
    s_mov_b32 exec_hi, -1
    s_add_u32 m0, s81, 0
    s_nop 0
    buffer_load_dwordx4 v240, s[40:43], s83 offen lds
    s_add_u32 m0, s82, 0
    s_nop 0
    buffer_load_dwordx4 v244, s[44:47], s84 offen lds
    s_add_u32 m0, s81, 1024
    s_nop 0
    buffer_load_dwordx4 v241, s[40:43], s83 offen lds
    s_add_u32 m0, s82, 1024
    s_nop 0
    buffer_load_dwordx4 v245, s[44:47], s84 offen lds
    s_add_u32 m0, s81, 2048
    s_nop 0
    buffer_load_dwordx4 v242, s[40:43], s83 offen lds
    s_add_u32 m0, s82, 2048
    s_nop 0
    buffer_load_dwordx4 v246, s[44:47], s84 offen lds
    s_add_u32 m0, s81, 3072
    s_nop 0
    buffer_load_dwordx4 v243, s[40:43], s83 offen lds
    s_add_u32 m0, s82, 3072
    s_nop 0
    buffer_load_dwordx4 v247, s[44:47], s84 offen lds
    s_add_u32 m0, s82, 4096
    s_mov_b32 exec_hi, 0
    buffer_load_dwordx4 v248, s[44:47], s84 offen lds
    s_mov_b32 exec_hi, -1
    s_waitcnt vmcnt(10)
    s_barrier
    s_add_u32 m0, s86, 36864
    s_nop 0
    buffer_load_dwordx4 v100, s[56:59], s88 offen lds
    s_add_u32 m0, s86, 37888
    s_nop 0
    buffer_load_dwordx4 v101, s[56:59], s88 offen lds
    s_add_u32 m0, s86, 38912
    s_nop 0
    buffer_load_dwordx4 v102, s[56:59], s88 offen lds
    s_add_u32 m0, s86, 39936
    s_nop 0
    buffer_load_dwordx4 v103, s[56:59], s88 offen lds
    s_add_u32 m0, s86, 40960
    s_nop 0
    buffer_load_dwordx4 v104, s[56:59], s88 offen lds
    s_add_u32 m0, s86, 41984
    s_nop 0
    buffer_load_dwordx4 v105, s[56:59], s88 offen lds
    s_add_u32 m0, s86, 43008
    s_nop 0
    buffer_load_dwordx4 v106, s[56:59], s88 offen lds
    s_add_u32 m0, s86, 44032
    s_nop 0
    buffer_load_dwordx4 v107, s[56:59], s88 offen lds
    s_waitcnt vmcnt(8)
    s_barrier
    s_mov_b32 s38, 400000
    s_mov_b32 exec_hi, 3
L_ld_stchk:
    ds_read_b128 v[4:7], v132
    s_waitcnt lgkmcnt(0)
    v_min3_u32 v4, v4, v5, v6
    v_min_u32 v4, v4, v7
    v_cmp_eq_u32 vcc, 0, v4
    s_cbranch_vccz L_ld_stok
    s_mov_b32 m0, s91
    s_mov_b32 exec_hi, 3
    buffer_load_dwordx4 v131, s[48:51], s90 offen sc1 lds
    s_waitcnt vmcnt(0)
    s_sub_u32 s38, s38, 1
    s_cbranch_scc0 L_ld_stchk
L_ld_stok:
    s_mov_b64 exec, -1
    s_add_u32 m0, s86, 45056
    s_nop 0
    buffer_load_dwordx4 v108, s[56:59], s88 offen lds
    s_add_u32 m0, s86, 73728
    s_nop 0
    buffer_load_dwordx4 v109, s[56:59], s88 offen lds
    s_add_u32 m0, s86, 74752
    s_nop 0
    buffer_load_dwordx4 v110, s[56:59], s88 offen lds
    s_add_u32 m0, s86, 75776
    s_nop 0
    buffer_load_dwordx4 v111, s[56:59], s88 offen lds
    s_add_u32 m0, s86, 76800
    s_nop 0
    buffer_load_dwordx4 v112, s[56:59], s88 offen lds
    s_add_u32 m0, s86, 77824
    s_nop 0
    buffer_load_dwordx4 v113, s[56:59], s88 offen lds
    s_add_u32 m0, s86, 78848
    s_nop 0
    buffer_load_dwordx4 v114, s[56:59], s88 offen lds
    s_add_u32 m0, s86, 79872
    s_nop 0
    buffer_load_dwordx4 v115, s[56:59], s88 offen lds
    s_barrier
    s_add_u32 m0, s86, 80896
    s_nop 0
    buffer_load_dwordx4 v116, s[56:59], s88 offen lds
    s_add_u32 m0, s86, 81920
    s_nop 0
    buffer_load_dwordx4 v117, s[56:59], s88 offen lds
    s_add_u32 m0, s86, 110592
    s_nop 0
    buffer_load_dwordx4 v118, s[56:59], s88 offen lds
    s_add_u32 m0, s86, 111616
    s_nop 0
    buffer_load_dwordx4 v119, s[56:59], s88 offen lds
    s_add_u32 m0, s86, 112640
    s_nop 0
    buffer_load_dwordx4 v120, s[56:59], s88 offen lds
    s_add_u32 m0, s86, 113664
    s_nop 0
    buffer_load_dwordx4 v121, s[56:59], s88 offen lds
    s_add_u32 m0, s86, 114688
    s_nop 0
    buffer_load_dwordx4 v122, s[56:59], s88 offen lds
    s_cmp_ge_u32 s7, 4
    s_cbranch_scc1 L_ld_nowp
    s_cmp_lg_u32 s92, 0
    s_cbranch_scc1 L_ld_noz
    v_mov_b32 v4, 0
    v_mov_b32 v5, 0
    v_mov_b32 v6, 0
    v_mov_b32 v7, 0
    s_lshl_b32 s14, s75, 10
    s_add_u32 s14, s14, 3538944
    buffer_store_dwordx4 v[4:7], v11, s[48:51], s14 offen sc1
    s_add_u32 s14, s14, 262144
    buffer_store_dwordx4 v[4:7], v11, s[48:51], s14 offen sc1
    s_add_u32 s14, s14, 262144
    buffer_store_dwordx4 v[4:7], v11, s[48:51], s14 offen sc1
    s_add_u32 s14, s14, 262144
    buffer_store_dwordx4 v[4:7], v11, s[48:51], s14 offen sc1
L_ld_noz:
    s_mov_b32 s38, 1600000
L_cw_1:
    ds_read_b32 v1, v252 offset:12
    s_waitcnt lgkmcnt(0)
    v_readfirstlane_b32 s14, v1
    s_nop 0
    s_cmp_ge_u32 s14, 4
    s_cbranch_scc1 L_cok_2
    s_sleep 1
    s_sub_u32 s38, s38, 1
    s_cbranch_scc0 L_cw_1
L_cok_2:
L_ld_nowp:
    s_add_u32 m0, s86, 115712
    s_nop 0
    buffer_load_dwordx4 v123, s[56:59], s88 offen lds
    s_add_u32 m0, s86, 116736
    s_nop 0
    buffer_load_dwordx4 v124, s[56:59], s88 offen lds
    s_add_u32 m0, s86, 117760
    s_nop 0
    buffer_load_dwordx4 v125, s[56:59], s88 offen lds
    s_add_u32 m0, s86, 118784
    s_nop 0
    buffer_load_dwordx4 v126, s[56:59], s88 offen lds
    s_lshl2_add_u32 s14, s11, s80
    s_mul_i32 s14, s14, 18432
    s_add_u32 s14, s14, s88
    s_mul_i32 s15, s80, 3072
    s_add_u32 m0, s15, 147456
    s_nop 0
    buffer_load_dwordx4 v128, s[40:43], s14 offen lds
    s_add_u32 m0, s15, 148480
    s_nop 0
    buffer_load_dwordx4 v129, s[40:43], s14 offen lds
    s_add_u32 m0, s15, 149504
    s_nop 0
    buffer_load_dwordx4 v130, s[40:43], s14 offen lds
    s_mov_b32 m0, 162816
    s_mov_b32 exec_lo, 0xfff
    s_mov_b32 exec_hi, 0
    buffer_load_dwordx4 v11, s[64:67], s88 offen lds
    s_mov_b64 exec, -1
    s_waitcnt vmcnt(0)
    s_mov_b64 exec, 1
    ds_add_u32 v252, v253 offset:16
    s_mov_b64 exec, -1
    s_cmp_eq_u32 s92, 0
    s_cbranch_scc1 L_ld_red
    s_mov_b32 s38, 1600000
L_cw_3:
    ds_read_b32 v1, v252 offset:16
    s_waitcnt lgkmcnt(0)
    v_readfirstlane_b32 s14, v1
    s_nop 0
    s_cmp_ge_u32 s14, 4
    s_cbranch_scc1 L_cok_4
    s_sub_u32 s38, s38, 1
    s_cbranch_scc0 L_cw_3
L_cok_4:
    ds_read_b64_tr_b16 v[144:145], v8 offset:0
    ds_read_b64_tr_b16 v[146:147], v8 offset:3072
    ds_read_b64_tr_b16 v[148:149], v9 offset:0
    ds_read_b64_tr_b16 v[150:151], v9 offset:3072
    ds_read_b64_tr_b16 v[152:153], v10 offset:0
    ds_read_b64_tr_b16 v[154:155], v10 offset:3072
    s_waitcnt lgkmcnt(8)
    ds_read_b64_tr_b16 v[156:157], v8 offset:6144
    ds_read_b64_tr_b16 v[158:159], v8 offset:9216
    ds_read_b64_tr_b16 v[160:161], v9 offset:6144
    ds_read_b64_tr_b16 v[162:163], v9 offset:9216
    ds_read_b64_tr_b16 v[164:165], v10 offset:6144
    ds_read_b64_tr_b16 v[166:167], v10 offset:9216
    s_waitcnt lgkmcnt(8)
    ds_read_b64_tr_b16 v[168:169], v8 offset:12288
    ds_read_b64_tr_b16 v[170:171], v8 offset:15360
    ds_read_b64_tr_b16 v[172:173], v9 offset:12288
    ds_read_b64_tr_b16 v[174:175], v9 offset:15360
    ds_read_b64_tr_b16 v[176:177], v10 offset:12288
    ds_read_b64_tr_b16 v[178:179], v10 offset:15360
    s_waitcnt lgkmcnt(8)
    ds_read_b64_tr_b16 v[180:181], v8 offset:18432
    ds_read_b64_tr_b16 v[182:183], v8 offset:21504
    ds_read_b64_tr_b16 v[184:185], v9 offset:18432
    ds_read_b64_tr_b16 v[186:187], v9 offset:21504
    ds_read_b64_tr_b16 v[188:189], v10 offset:18432
    ds_read_b64_tr_b16 v[190:191], v10 offset:21504
    s_waitcnt lgkmcnt(8)
    ds_read_b64_tr_b16 v[192:193], v8 offset:24576
    ds_read_b64_tr_b16 v[194:195], v8 offset:27648
    ds_read_b64_tr_b16 v[196:197], v9 offset:24576
    ds_read_b64_tr_b16 v[198:199], v9 offset:27648
    ds_read_b64_tr_b16 v[200:201], v10 offset:24576
    ds_read_b64_tr_b16 v[202:203], v10 offset:27648
    s_waitcnt lgkmcnt(8)
    ds_read_b64_tr_b16 v[204:205], v8 offset:30720
    ds_read_b64_tr_b16 v[206:207], v8 offset:33792
    ds_read_b64_tr_b16 v[208:209], v9 offset:30720
    ds_read_b64_tr_b16 v[210:211], v9 offset:33792
    ds_read_b64_tr_b16 v[212:213], v10 offset:30720
    ds_read_b64_tr_b16 v[214:215], v10 offset:33792
    s_waitcnt lgkmcnt(8)
    ds_read_b64_tr_b16 v[216:217], v8 offset:36864
    ds_read_b64_tr_b16 v[218:219], v8 offset:39936
    ds_read_b64_tr_b16 v[220:221], v9 offset:36864
    ds_read_b64_tr_b16 v[222:223], v9 offset:39936
    ds_read_b64_tr_b16 v[224:225], v10 offset:36864
    ds_read_b64_tr_b16 v[226:227], v10 offset:39936
    s_waitcnt lgkmcnt(8)
    ds_read_b64_tr_b16 v[228:229], v8 offset:43008
    ds_read_b64_tr_b16 v[230:231], v8 offset:46080
    ds_read_b64_tr_b16 v[232:233], v9 offset:43008
    ds_read_b64_tr_b16 v[234:235], v9 offset:46080
    ds_read_b64_tr_b16 v[236:237], v10 offset:43008
    ds_read_b64_tr_b16 v[238:239], v10 offset:46080
    s_waitcnt lgkmcnt(8)
    ds_read_b64_tr_b16 v[240:241], v8 offset:49152
    ds_read_b64_tr_b16 v[242:243], v8 offset:52224
    ds_read_b64_tr_b16 v[244:245], v9 offset:49152
    ds_read_b64_tr_b16 v[246:247], v9 offset:52224
    ds_read_b64_tr_b16 v[248:249], v10 offset:49152
    ds_read_b64_tr_b16 v[250:251], v10 offset:52224
    s_waitcnt lgkmcnt(8)
    s_mov_b32 s93, 0
    s_waitcnt lgkmcnt(0)
    s_mov_b64 exec, 1
    ds_add_u32 v252, v253 offset:32
    s_mov_b64 exec, -1
    s_cmp_lg_u32 s92, 0
    s_cbranch_scc1 L_phaseB
L_ld_red:
    s_mov_b32 s93, 0
    s_mov_b32 s38, 1600000
L_cw_5:
    ds_read_b32 v1, v252 offset:4
    s_waitcnt lgkmcnt(0)
    v_readfirstlane_b32 s14, v1
    s_nop 0
    s_cmp_ge_u32 s14, 4
    s_cbranch_scc1 L_cok_6
    s_sleep 1
    s_sub_u32 s38, s38, 1
    s_cbranch_scc0 L_cw_5
L_cok_6:
    s_sleep 4
    s_mov_b64 exec, s[76:77]
    s_mov_b32 s38, 400000
L_H_kvp:
    buffer_load_dwordx4 v[24:27], v40, s[48:51], s74 offen sc1
    buffer_load_dwordx4 v[28:31], v41, s[48:51], s74 offen sc1
    buffer_load_dwordx4 v[32:35], v42, s[48:51], s74 offen sc1
    buffer_load_dwordx4 v[36:39], v43, s[48:51], s74 offen sc1
    s_waitcnt vmcnt(0)
    v_min3_u32 v4, v24, v25, v26
    v_min3_u32 v5, v27, v28, v29
    v_min3_u32 v4, v4, v30, v31
    v_min3_u32 v5, v5, v32, v33
    v_min3_u32 v4, v4, v34, v35
    v_min3_u32 v5, v5, v36, v37
    v_min3_u32 v4, v4, v38, v39
    v_min_u32 v4, v4, v5
    v_cmp_eq_u32 vcc, 0, v4
    s_nop 0
    s_and_b64 exec, exec, vcc
    s_cbranch_scc0 L_H_kvp_ok
    s_sub_u32 s38, s38, 1
    s_cbranch_scc0 L_H_kvp
L_H_kvp_ok:
    s_mov_b64 exec, 63
    buffer_load_dword v142, v140, s[48:51], s19 offen sc1
    s_mov_b64 exec, 1
    buffer_store_dword v253, v44, s[48:51], s78 offen
    s_mov_b64 exec, -1
    v_pk_add_f32 v[24:25], v[24:25], v[28:29]
    v_pk_add_f32 v[32:33], v[32:33], v[36:37]
    v_pk_add_f32 v[26:27], v[26:27], v[30:31]
    v_pk_add_f32 v[34:35], v[34:35], v[38:39]
    v_pk_add_f32 v[24:25], v[24:25], v[32:33]
    v_pk_add_f32 v[26:27], v[26:27], v[34:35]
    s_nop 1
    v_permlane32_swap_b32 v24, v26
    v_permlane32_swap_b32 v25, v27
    v_pk_add_f32 v[24:25], v[24:25], v[26:27]
    v_mov_b32 v26, v24
    v_mov_b32 v27, v25
    s_nop 0
    v_permlane16_swap_b32 v24, v26
    v_permlane16_swap_b32 v25, v27
    v_pk_add_f32 v[24:25], v[24:25], v[26:27]
    v_mov_b32 v7, 0x80008000
    v_cvt_pk_bf16_f32 v24, v24, v25
    v_cmp_eq_u32 vcc, 0, v24
    s_and_b32 s76, s76, 0xffff
    s_mov_b32 s77, 0
    v_cndmask_b32 v24, v24, v7, vcc
    v_cndmask_b32 v25, v24, v7, vcc
    s_nop 1
    v_permlane32_swap_b32 v24, v25
    s_mov_b64 exec, s[76:77]
    buffer_store_dwordx2 v[24:25], v44, s[48:51], s73 offen sc1
    s_mov_b64 exec, 1
    ds_add_u32 v252, v253 offset:8
    s_mov_b64 exec, -1
    s_mov_b32 s38, 1600000
L_cw_7:
    ds_read_b32 v1, v252 offset:16
    s_waitcnt lgkmcnt(0)
    v_readfirstlane_b32 s14, v1
    s_nop 0
    s_cmp_ge_u32 s14, 4
    s_cbranch_scc1 L_cok_8
    s_sub_u32 s38, s38, 1
    s_cbranch_scc0 L_cw_7
L_cok_8:
    ds_read_b64_tr_b16 v[144:145], v8 offset:0
    ds_read_b64_tr_b16 v[146:147], v8 offset:3072
    ds_read_b64_tr_b16 v[148:149], v9 offset:0
    ds_read_b64_tr_b16 v[150:151], v9 offset:3072
    ds_read_b64_tr_b16 v[152:153], v10 offset:0
    ds_read_b64_tr_b16 v[154:155], v10 offset:3072
    s_waitcnt lgkmcnt(8)
    ds_read_b64_tr_b16 v[156:157], v8 offset:6144
    ds_read_b64_tr_b16 v[158:159], v8 offset:9216
    ds_read_b64_tr_b16 v[160:161], v9 offset:6144
    ds_read_b64_tr_b16 v[162:163], v9 offset:9216
    ds_read_b64_tr_b16 v[164:165], v10 offset:6144
    ds_read_b64_tr_b16 v[166:167], v10 offset:9216
    s_waitcnt lgkmcnt(8)
    ds_read_b64_tr_b16 v[168:169], v8 offset:12288
    ds_read_b64_tr_b16 v[170:171], v8 offset:15360
    ds_read_b64_tr_b16 v[172:173], v9 offset:12288
    ds_read_b64_tr_b16 v[174:175], v9 offset:15360
    ds_read_b64_tr_b16 v[176:177], v10 offset:12288
    ds_read_b64_tr_b16 v[178:179], v10 offset:15360
    s_waitcnt lgkmcnt(8)
    ds_read_b64_tr_b16 v[180:181], v8 offset:18432
    ds_read_b64_tr_b16 v[182:183], v8 offset:21504
    ds_read_b64_tr_b16 v[184:185], v9 offset:18432
    ds_read_b64_tr_b16 v[186:187], v9 offset:21504
    ds_read_b64_tr_b16 v[188:189], v10 offset:18432
    ds_read_b64_tr_b16 v[190:191], v10 offset:21504
    s_waitcnt lgkmcnt(8)
    ds_read_b64_tr_b16 v[192:193], v8 offset:24576
    ds_read_b64_tr_b16 v[194:195], v8 offset:27648
    ds_read_b64_tr_b16 v[196:197], v9 offset:24576
    ds_read_b64_tr_b16 v[198:199], v9 offset:27648
    ds_read_b64_tr_b16 v[200:201], v10 offset:24576
    ds_read_b64_tr_b16 v[202:203], v10 offset:27648
    s_waitcnt lgkmcnt(8)
    ds_read_b64_tr_b16 v[204:205], v8 offset:30720
    ds_read_b64_tr_b16 v[206:207], v8 offset:33792
    ds_read_b64_tr_b16 v[208:209], v9 offset:30720
    ds_read_b64_tr_b16 v[210:211], v9 offset:33792
    ds_read_b64_tr_b16 v[212:213], v10 offset:30720
    ds_read_b64_tr_b16 v[214:215], v10 offset:33792
    s_waitcnt lgkmcnt(8)
    ds_read_b64_tr_b16 v[216:217], v8 offset:36864
    ds_read_b64_tr_b16 v[218:219], v8 offset:39936
    ds_read_b64_tr_b16 v[220:221], v9 offset:36864
    ds_read_b64_tr_b16 v[222:223], v9 offset:39936
    ds_read_b64_tr_b16 v[224:225], v10 offset:36864
    ds_read_b64_tr_b16 v[226:227], v10 offset:39936
    s_waitcnt lgkmcnt(8)
    ds_read_b64_tr_b16 v[228:229], v8 offset:43008
    ds_read_b64_tr_b16 v[230:231], v8 offset:46080
    ds_read_b64_tr_b16 v[232:233], v9 offset:43008
    ds_read_b64_tr_b16 v[234:235], v9 offset:46080
    ds_read_b64_tr_b16 v[236:237], v10 offset:43008
    ds_read_b64_tr_b16 v[238:239], v10 offset:46080
    s_waitcnt lgkmcnt(8)
    ds_read_b64_tr_b16 v[240:241], v8 offset:49152
    ds_read_b64_tr_b16 v[242:243], v8 offset:52224
    ds_read_b64_tr_b16 v[244:245], v9 offset:49152
    ds_read_b64_tr_b16 v[246:247], v9 offset:52224
    ds_read_b64_tr_b16 v[248:249], v10 offset:49152
    ds_read_b64_tr_b16 v[250:251], v10 offset:52224
    s_waitcnt lgkmcnt(8)
    s_waitcnt lgkmcnt(0)
    s_mov_b64 exec, 1
    ds_add_u32 v252, v253 offset:32
    s_mov_b64 exec, -1
    s_mov_b32 s38, 400000
    s_mov_b64 exec, 63
    s_waitcnt vmcnt(2)
    s_branch L_pqchk
    .fill 562, 4, 0xbf810000
L_compute:
    s_add_u32 s85, s85, 1
    s_cmp_eq_u32 s85, 9
    s_cselect_b32 s85, 0, s85
    s_lshl_b32 s83, s85, 7
    s_add_u32 s83, s83, s87
    s_mul_i32 s84, s85, 221184
    s_add_u32 s84, s84, s8
    s_add_u32 m0, s81, 36864
    s_nop 0
    buffer_load_dwordx4 v240, s[40:43], s83 offen lds
    v_lshrrev_b32 v4, 1, v2
    v_xor_b32 v4, v4, v3
    v_lshlrev_b32 v4, 4, v4
    v_lshl_add_u32 v4, v2, 7, v4
    v_add_u32 v8, s81, v4
    v_xor_b32 v9, 64, v8
    v_lshrrev_b32 v4, 2, v0
    v_mul_u32_u24 v4, 288, v4
    v_and_b32 v5, 3, v0
    v_lshl_add_u32 v4, v5, 3, v4
    v_add_u32 v10, 16384, v4
    v_mov_b32 v11, v8
    v_mov_b32 v12, v9
    v_mov_b32 v13, v10
    v_mov_b32 v16, 0
    v_mov_b32 v17, 0
    v_mov_b32 v18, 0
    v_mov_b32 v19, 0
    v_mov_b32 v20, 0
    s_add_u32 m0, s82, 36864
    s_nop 0
    buffer_load_dwordx4 v244, s[44:47], s84 offen lds
    v_mov_b32 v21, 0
    v_mov_b32 v22, 0
    v_mov_b32 v23, 0
    v_mov_b32 v24, 0
    v_mov_b32 v25, 0
    v_mov_b32 v26, 0
    v_mov_b32 v27, 0
    v_mov_b32 v28, 0
    v_mov_b32 v29, 0
    v_mov_b32 v30, 0
    v_mov_b32 v31, 0
    v_mov_b32 v32, 0
    v_mov_b32 v33, 0
    v_mov_b32 v34, 0
    v_mov_b32 v35, 0
    v_mov_b32 v36, 0
    v_mov_b32 v37, 0
    v_mov_b32 v38, 0
    v_mov_b32 v39, 0
    s_add_u32 m0, s81, 37888
    s_nop 0
    buffer_load_dwordx4 v241, s[40:43], s83 offen lds
    v_mov_b32 v40, 0
    v_mov_b32 v41, 0
    v_mov_b32 v42, 0
    v_mov_b32 v43, 0
    v_mov_b32 v44, 0
    v_mov_b32 v45, 0
    v_mov_b32 v46, 0
    v_mov_b32 v47, 0
    v_mov_b32 v48, 0
    v_mov_b32 v49, 0
    v_mov_b32 v50, 0
    v_mov_b32 v51, 0
    v_mov_b32 v52, 0
    v_mov_b32 v53, 0
    v_mov_b32 v54, 0
    v_mov_b32 v55, 0
    v_mov_b32 v56, 0
    v_mov_b32 v57, 0
    v_mov_b32 v58, 0
    s_add_u32 m0, s82, 37888
    s_nop 0
    buffer_load_dwordx4 v245, s[44:47], s84 offen lds
    v_mov_b32 v59, 0
    v_mov_b32 v60, 0
    v_mov_b32 v61, 0
    v_mov_b32 v62, 0
    v_mov_b32 v63, 0
    v_mov_b32 v64, 0
    v_mov_b32 v65, 0
    v_mov_b32 v66, 0
    v_mov_b32 v67, 0
    v_mov_b32 v68, 0
    v_mov_b32 v69, 0
    v_mov_b32 v70, 0
    v_mov_b32 v71, 0
    v_mov_b32 v72, 0
    v_mov_b32 v73, 0
    v_mov_b32 v74, 0
    v_mov_b32 v75, 0
    v_mov_b32 v76, 0
    v_mov_b32 v77, 0
    s_add_u32 m0, s81, 38912
    s_nop 0
    buffer_load_dwordx4 v242, s[40:43], s83 offen lds
    v_mov_b32 v78, 0
    v_mov_b32 v79, 0
    v_mov_b32 v80, 0
    v_mov_b32 v81, 0
    v_mov_b32 v82, 0
    v_mov_b32 v83, 0
    v_mov_b32 v84, 0
    v_mov_b32 v85, 0
    v_mov_b32 v86, 0
    v_mov_b32 v87, 0
    v_mov_b32 v176, 0
    v_mov_b32 v177, 0
    v_mov_b32 v178, 0
    v_mov_b32 v179, 0
    v_mov_b32 v180, 0
    v_mov_b32 v181, 0
    v_mov_b32 v182, 0
    v_mov_b32 v183, 0
    v_mov_b32 v184, 0
    s_add_u32 m0, s82, 38912
    s_nop 0
    buffer_load_dwordx4 v246, s[44:47], s84 offen lds
    v_mov_b32 v185, 0
    v_mov_b32 v186, 0
    v_mov_b32 v187, 0
    v_mov_b32 v188, 0
    v_mov_b32 v189, 0
    v_mov_b32 v190, 0
    v_mov_b32 v191, 0
    v_mov_b32 v192, 0
    v_mov_b32 v193, 0
    v_mov_b32 v194, 0
    v_mov_b32 v195, 0
    v_mov_b32 v196, 0
    v_mov_b32 v197, 0
    v_mov_b32 v198, 0
    v_mov_b32 v199, 0
    v_mov_b32 v200, 0
    v_mov_b32 v201, 0
    v_mov_b32 v202, 0
    v_mov_b32 v203, 0
    s_add_u32 m0, s81, 39936
    s_nop 0
    buffer_load_dwordx4 v243, s[40:43], s83 offen lds
    v_mov_b32 v204, 0
    v_mov_b32 v205, 0
    v_mov_b32 v206, 0
    v_mov_b32 v207, 0
    v_mov_b32 v208, 0x3f803f80
    v_mov_b32 v209, 0x3f803f80
    v_mov_b32 v210, 0x3f803f80
    v_mov_b32 v211, 0x3f803f80
    v_mov_b32 v212, 0x3f803f80
    v_mov_b32 v213, 0x3f803f80
    v_mov_b32 v214, 0x3f803f80
    v_mov_b32 v215, 0x3f803f80
    v_mov_b32 v216, 0x3f803f80
    v_mov_b32 v217, 0x3f803f80
    v_mov_b32 v218, 0x3f803f80
    v_mov_b32 v219, 0x3f803f80
    v_mov_b32 v220, 0x3f803f80
    v_mov_b32 v221, 0x3f803f80
    v_mov_b32 v222, 0x3f803f80
    s_add_u32 m0, s82, 39936
    s_nop 0
    buffer_load_dwordx4 v247, s[44:47], s84 offen lds
    v_mov_b32 v223, 0x3f803f80
    v_mov_b32 v224, 0x3f803f80
    v_mov_b32 v225, 0x3f803f80
    v_mov_b32 v226, 0x3f803f80
    v_mov_b32 v227, 0x3f803f80
    v_mov_b32 v228, 0x3f803f80
    v_mov_b32 v229, 0x3f803f80
    v_mov_b32 v230, 0x3f803f80
    v_mov_b32 v231, 0x3f803f80
    v_mov_b32 v232, 0x3f803f80
    v_mov_b32 v233, 0x3f803f80
    v_mov_b32 v234, 0x3f803f80
    v_mov_b32 v235, 0x3f803f80
    v_mov_b32 v236, 0x3f803f80
    v_mov_b32 v237, 0x3f803f80
    v_mov_b32 v238, 0x3f803f80
    v_mov_b32 v239, 0x3f803f80
    s_add_u32 m0, s82, 40960
    s_mov_b32 exec_hi, 0
    buffer_load_dwordx4 v248, s[44:47], s84 offen lds
    s_mov_b32 exec_hi, -1
    s_mul_i32 s11, s5, 43
    s_lshr_b32 s11, s11, 8
    s_mul_i32 s12, s11, 6
    s_sub_u32 s12, s5, s12
    s_and_b32 s15, s4, 3
    s_lshl3_add_u32 s11, s15, s11
    s_lshl2_add_u32 s11, s10, s11
    s_mov_b32 s48, s36
    s_mov_b32 s49, s37
    s_mov_b32 s50, 4526080
    s_mov_b32 s51, 0x20000
    s_mov_b32 s60, s32
    s_mov_b32 s61, s33
    s_mov_b32 s62, 2359296
    s_mov_b32 s63, 0x20000
    s_mov_b32 s82, 0x358637bd
    s_mov_b32 s83, 0x358637bd
    s_mov_b32 s84, 0x3fb8aa3b
    s_mov_b32 s85, 0x3fb8aa3b
    s_mov_b32 s93, 0
    s_mov_b32 s80, 0
    s_mov_b32 s81, 9
    s_cmp_ge_u32 s7, 4
    s_cbranch_scc1 L_q
    s_lshl_b32 s14, s3, 10
    v_lshl_add_u32 v240, v0, 4, s14
    v_and_b32 v4, 31, v0
    v_lshrrev_b32 v5, 5, v0
    s_lshl_b32 s14, s3, 4
    v_add_u32 v6, s14, v4
    v_lshrrev_b32 v1, 4, v6
    v_lshlrev_b32 v1, 12, v1
    v_and_b32 v6, 15, v6
    v_lshl_add_u32 v1, v6, 4, v1
    v_lshl_add_u32 v241, v5, 8, v1
    s_mul_i32 s14, s3, 18
    s_add_u32 s14, s14, 72
    v_add_u32 v7, s14, v4
    v_lshrrev_b32 v1, 4, v7
    v_lshlrev_b32 v1, 12, v1
    v_and_b32 v7, 15, v7
    v_lshl_add_u32 v1, v7, 4, v1
    v_lshl_add_u32 v242, v5, 8, v1
    v_and_b32 v1, 7, v0
    v_lshlrev_b32 v1, 4, v1
    v_bfe_u32 v6, v0, 3, 1
    v_lshl_add_u32 v6, v6, 8, v1
    v_lshl_add_u32 v6, v5, 7, v6
    v_lshl_add_u32 v7, v5, 6, v1
    v_add_u32 v7, 1536, v7
    v_cmp_gt_u32 vcc, 16, v4
    v_mov_b32 v1, 128
    v_mov_b32 v5, 512
    v_cndmask_b32 v243, v7, v6, vcc
    v_cndmask_b32 v1, v1, v5, vcc
    v_add_u32 v244, v243, v1
    v_add_u32 v245, v244, v1
    s_mul_i32 s14, s3, 544
    s_add_u32 s14, s14, 159744
    v_lshl_add_u32 v14, v3, 4, s14
    v_lshlrev_b32 v4, 2, v2
    v_add_u32 v15, 160000, v4
    v_add_u32 v248, 800, v15
    v_cmp_gt_u32 vcc, 32, v4
    s_nop 1
    v_cndmask_b32 v249, v248, v15, vcc
    v_add_u32 v248, 320, v248
    v_cmp_gt_u32 s[86:87], 8, v2
    v_mov_b32 v1, s82
    s_nop 0
    v_cndmask_b32 v246, 0, v1, s[86:87]
    v_mov_b32 v247, v246
    s_lshl_b32 s14, s3, 1
    s_lshl_b32 s88, 0x3ffff, s14
    s_mov_b32 s89, s88
    s_lshl2_add_u32 s14, s13, s3
    s_lshl4_add_u32 s14, s14, s6
    s_lshl_b32 s14, s14, 11
    s_add_u32 s90, s14, 2359296
    s_lshl_b32 s14, s4, 10
    s_lshl2_add_u32 s14, s5, s14
    s_add_u32 s91, s14, 3489984
    s_waitcnt vmcnt(9)
    s_barrier
    ds_read_b128 v[88:91], v11 offset:0
    ds_read_b128 v[92:95], v11 offset:2048
    ds_read_b64_tr_b16 v[104:105], v13 offset:0
    ds_read_b64_tr_b16 v[106:107], v13 offset:4608
    ds_read_b64_tr_b16 v[108:109], v13 offset:32
    ds_read_b64_tr_b16 v[110:111], v13 offset:4640
    ds_read_b64_tr_b16 v[112:113], v13 offset:64
    ds_read_b64_tr_b16 v[114:115], v13 offset:4672
    ds_read_b64_tr_b16 v[116:117], v13 offset:96
    ds_read_b64_tr_b16 v[118:119], v13 offset:4704
    ds_read_b64_tr_b16 v[120:121], v13 offset:128
    ds_read_b64_tr_b16 v[122:123], v13 offset:4736
    ds_read_b64_tr_b16 v[124:125], v13 offset:160
    ds_read_b64_tr_b16 v[126:127], v13 offset:4768
L_kvloop:
    s_waitcnt lgkmcnt(10)
    v_mfma_f32_16x16x32_bf16 v[16:19], v[88:91], v[104:107], v[16:19]
    ds_read_b64_tr_b16 v[128:129], v13 offset:192
    ds_read_b64_tr_b16 v[130:131], v13 offset:4800
    ds_read_b64_tr_b16 v[132:133], v13 offset:224
    ds_read_b64_tr_b16 v[134:135], v13 offset:4832
    v_mfma_f32_16x16x32_bf16 v[20:23], v[92:95], v[104:107], v[20:23]
    s_waitcnt lgkmcnt(12)
    v_mfma_f32_16x16x32_bf16 v[24:27], v[88:91], v[108:111], v[24:27]
    ds_read_b64_tr_b16 v[136:137], v13 offset:256
    ds_read_b64_tr_b16 v[138:139], v13 offset:4864
    v_mfma_f32_16x16x32_bf16 v[28:31], v[92:95], v[108:111], v[28:31]
    s_waitcnt lgkmcnt(12)
    v_mfma_f32_16x16x32_bf16 v[32:35], v[88:91], v[112:115], v[32:35]
    ds_read_b128 v[96:99], v12 offset:0
    ds_read_b128 v[100:103], v12 offset:2048
    v_mfma_f32_16x16x32_bf16 v[36:39], v[92:95], v[112:115], v[36:39]
    s_waitcnt lgkmcnt(12)
    v_mfma_f32_16x16x32_bf16 v[40:43], v[88:91], v[116:119], v[40:43]
    ds_read_b64_tr_b16 v[140:141], v13 offset:9216
    ds_read_b64_tr_b16 v[142:143], v13 offset:13824
    v_mfma_f32_16x16x32_bf16 v[44:47], v[92:95], v[116:119], v[44:47]
    s_waitcnt lgkmcnt(12)
    v_mfma_f32_16x16x32_bf16 v[48:51], v[88:91], v[120:123], v[48:51]
    ds_read_b64_tr_b16 v[144:145], v13 offset:9248
    ds_read_b64_tr_b16 v[146:147], v13 offset:13856
    v_mfma_f32_16x16x32_bf16 v[52:55], v[92:95], v[120:123], v[52:55]
    s_waitcnt lgkmcnt(12)
    v_mfma_f32_16x16x32_bf16 v[56:59], v[88:91], v[124:127], v[56:59]
    ds_read_b64_tr_b16 v[148:149], v13 offset:9280
    ds_read_b64_tr_b16 v[150:151], v13 offset:13888
    v_mfma_f32_16x16x32_bf16 v[60:63], v[92:95], v[124:127], v[60:63]
    s_waitcnt lgkmcnt(12)
    v_mfma_f32_16x16x32_bf16 v[64:67], v[88:91], v[128:131], v[64:67]
    ds_read_b64_tr_b16 v[152:153], v13 offset:9312
    ds_read_b64_tr_b16 v[154:155], v13 offset:13920
    v_mfma_f32_16x16x32_bf16 v[68:71], v[92:95], v[128:131], v[68:71]
    s_waitcnt lgkmcnt(12)
    v_mfma_f32_16x16x32_bf16 v[72:75], v[88:91], v[132:135], v[72:75]
    ds_read_b64_tr_b16 v[156:157], v13 offset:9344
    ds_read_b64_tr_b16 v[158:159], v13 offset:13952
    v_mfma_f32_16x16x32_bf16 v[76:79], v[92:95], v[132:135], v[76:79]
    s_waitcnt lgkmcnt(12)
    v_mfma_f32_16x16x32_bf16 v[80:83], v[88:91], v[136:139], v[80:83]
    ds_read_b64_tr_b16 v[160:161], v13 offset:9376
    ds_read_b64_tr_b16 v[162:163], v13 offset:13984
    v_mfma_f32_16x16x32_bf16 v[84:87], v[92:95], v[136:139], v[84:87]
    s_waitcnt lgkmcnt(10)
    v_mfma_f32_16x16x32_bf16 v[16:19], v[96:99], v[140:143], v[16:19]
    ds_read_b64_tr_b16 v[164:165], v13 offset:9408
    ds_read_b64_tr_b16 v[166:167], v13 offset:14016
    ds_read_b64_tr_b16 v[168:169], v13 offset:9440
    ds_read_b64_tr_b16 v[170:171], v13 offset:14048
    v_mfma_f32_16x16x32_bf16 v[20:23], v[100:103], v[140:143], v[20:23]
    s_waitcnt lgkmcnt(12)
    v_mfma_f32_16x16x32_bf16 v[24:27], v[96:99], v[144:147], v[24:27]
    ds_read_b64_tr_b16 v[172:173], v13 offset:9472
    ds_read_b64_tr_b16 v[174:175], v13 offset:14080
    v_mfma_f32_16x16x32_bf16 v[28:31], v[100:103], v[144:147], v[28:31]
    s_waitcnt lgkmcnt(12)
    v_mfma_f32_16x16x32_bf16 v[32:35], v[96:99], v[148:151], v[32:35]
    v_mfma_f32_16x16x32_bf16 v[36:39], v[100:103], v[148:151], v[36:39]
    s_waitcnt lgkmcnt(10)
    v_mfma_f32_16x16x32_bf16 v[40:43], v[96:99], v[152:155], v[40:43]
    s_add_u32 s80, s80, 36864
    s_cmp_eq_u32 s80, 147456
    s_cselect_b32 s80, 0, s80
    s_sub_u32 s81, s81, 1
    v_mfma_f32_16x16x32_bf16 v[44:47], v[100:103], v[152:155], v[44:47]
    v_add_u32 v11, s80, v8
    v_add_u32 v13, s80, v10
    v_add_u32 v12, s80, v9
    s_cmp_eq_u32 s81, 0
    s_waitcnt vmcnt(0) lgkmcnt(0)
    s_barrier
    s_cbranch_scc1 L_kvloop_tail
    ds_read_b128 v[88:91], v11 offset:0
    ds_read_b128 v[92:95], v11 offset:2048
    v_mfma_f32_16x16x32_bf16 v[48:51], v[96:99], v[156:159], v[48:51]
    ds_read_b64_tr_b16 v[104:105], v13 offset:0
    ds_read_b64_tr_b16 v[106:107], v13 offset:4608
    v_mfma_f32_16x16x32_bf16 v[52:55], v[100:103], v[156:159], v[52:55]
    ds_read_b64_tr_b16 v[108:109], v13 offset:32
    ds_read_b64_tr_b16 v[110:111], v13 offset:4640
    v_mfma_f32_16x16x32_bf16 v[56:59], v[96:99], v[160:163], v[56:59]
    ds_read_b64_tr_b16 v[112:113], v13 offset:64
    ds_read_b64_tr_b16 v[114:115], v13 offset:4672
    v_mfma_f32_16x16x32_bf16 v[60:63], v[100:103], v[160:163], v[60:63]
    ds_read_b64_tr_b16 v[116:117], v13 offset:96
    ds_read_b64_tr_b16 v[118:119], v13 offset:4704
    v_mfma_f32_16x16x32_bf16 v[64:67], v[96:99], v[164:167], v[64:67]
    ds_read_b64_tr_b16 v[120:121], v13 offset:128
    ds_read_b64_tr_b16 v[122:123], v13 offset:4736
    v_mfma_f32_16x16x32_bf16 v[68:71], v[100:103], v[164:167], v[68:71]
    ds_read_b64_tr_b16 v[124:125], v13 offset:160
    ds_read_b64_tr_b16 v[126:127], v13 offset:4768
    v_mfma_f32_16x16x32_bf16 v[72:75], v[96:99], v[168:171], v[72:75]
    v_mfma_f32_16x16x32_bf16 v[76:79], v[100:103], v[168:171], v[76:79]
    v_mfma_f32_16x16x32_bf16 v[80:83], v[96:99], v[172:175], v[80:83]
    v_mfma_f32_16x16x32_bf16 v[84:87], v[100:103], v[172:175], v[84:87]
    s_branch L_kvloop
L_kvloop_tail:
    ds_read_b128 v[104:107], v14 offset:0
    ds_read_b128 v[112:115], v14 offset:128
    ds_read_b128 v[108:111], v14 offset:64
    ds_read_b128 v[116:119], v14 offset:192
    ds_read2_b32 v[120:121], v15 offset0:0 offset1:136
    ds_read2_b32 v[122:123], v15 offset0:16 offset1:152
    ds_read2_b32 v[124:125], v15 offset0:32 offset1:168
    ds_read2_b32 v[126:127], v15 offset0:48 offset1:184
    ds_read2_b32 v[128:129], v249 offset0:64 offset1:200
    ds_read2_b32 v[130:131], v248 offset0:0 offset1:136
    ds_read2_b32 v[132:133], v248 offset0:16 offset1:152
    ds_read2_b32 v[134:135], v248 offset0:32 offset1:168
    ds_read2_b32 v[136:137], v248 offset0:48 offset1:184
    v_mfma_f32_16x16x32_bf16 v[48:51], v[96:99], v[156:159], v[48:51]
    v_mfma_f32_16x16x32_bf16 v[52:55], v[100:103], v[156:159], v[52:55]
    v_mfma_f32_16x16x32_bf16 v[56:59], v[96:99], v[160:163], v[56:59]
    v_mfma_f32_16x16x32_bf16 v[60:63], v[100:103], v[160:163], v[60:63]
    v_mfma_f32_16x16x32_bf16 v[64:67], v[96:99], v[164:167], v[64:67]
    v_mfma_f32_16x16x32_bf16 v[68:71], v[100:103], v[164:167], v[68:71]
    v_mfma_f32_16x16x32_bf16 v[72:75], v[96:99], v[168:171], v[72:75]
    v_mfma_f32_16x16x32_bf16 v[76:79], v[100:103], v[168:171], v[76:79]
    v_mfma_f32_16x16x32_bf16 v[80:83], v[96:99], v[172:175], v[80:83]
    v_mfma_f32_16x16x32_bf16 v[84:87], v[100:103], v[172:175], v[84:87]
    s_waitcnt lgkmcnt(0)
    v_add_f32 v120, v120, v121
    v_add_f32 v122, v122, v123
    v_add_f32 v124, v124, v125
    v_add_f32 v126, v126, v127
    v_add_f32 v128, v128, v129
    v_add_f32 v130, v130, v131
    v_add_f32 v132, v132, v133
    v_add_f32 v134, v134, v135
    v_add_f32 v136, v136, v137
    v_pk_fma_f32 v[140:141], v[112:113], v[120:121], s[82:83] op_sel:[0,0,0] op_sel_hi:[1,0,1]
    v_pk_fma_f32 v[144:145], v[114:115], v[120:121], s[82:83] op_sel:[0,0,0] op_sel_hi:[1,0,1]
    v_pk_fma_f32 v[148:149], v[116:117], v[120:121], s[82:83] op_sel:[0,0,0] op_sel_hi:[1,0,1]
    v_pk_fma_f32 v[152:153], v[118:119], v[120:121], s[82:83] op_sel:[0,0,0] op_sel_hi:[1,0,1]
    v_pk_fma_f32 v[16:17], v[16:17], v[104:105], v[140:141]
    v_pk_fma_f32 v[18:19], v[18:19], v[106:107], v[144:145]
    v_pk_fma_f32 v[20:21], v[20:21], v[108:109], v[148:149]
    v_pk_fma_f32 v[22:23], v[22:23], v[110:111], v[152:153]
    v_pk_mul_f32 v[140:141], v[16:17], s[84:85]
    v_pk_mul_f32 v[144:145], v[18:19], s[84:85]
    v_pk_mul_f32 v[148:149], v[20:21], s[84:85]
    v_pk_mul_f32 v[152:153], v[22:23], s[84:85]
    v_max_f32 v142, s82, v16
    v_max_f32 v146, s82, v18
    v_max_f32 v150, s82, v20
    v_max_f32 v154, s82, v22
    v_exp_f32 v140, v140 clamp
    v_exp_f32 v144, v144 clamp
    v_exp_f32 v148, v148 clamp
    v_exp_f32 v152, v152 clamp
    v_max_f32 v143, s82, v17
    v_max_f32 v147, s82, v19
    v_max_f32 v151, s82, v21
    v_max_f32 v155, s82, v23
    v_exp_f32 v141, v141 clamp
    v_exp_f32 v145, v145 clamp
    v_exp_f32 v149, v149 clamp
    v_exp_f32 v153, v153 clamp
    v_pk_add_f32 v[140:141], v[140:141], v[142:143]
    v_pk_add_f32 v[144:145], v[144:145], v[146:147]
    v_pk_add_f32 v[148:149], v[148:149], v[150:151]
    v_pk_add_f32 v[152:153], v[152:153], v[154:155]
    v_cvt_pk_bf16_f32 v16, v140, v141
    v_cvt_pk_bf16_f32 v17, v144, v145
    v_cvt_pk_bf16_f32 v18, v148, v149
    v_cvt_pk_bf16_f32 v19, v152, v153
    ds_write_b128 v240, v[16:19] offset:0
    v_pk_fma_f32 v[140:141], v[112:113], v[122:123], s[82:83] op_sel:[0,0,0] op_sel_hi:[1,0,1]
    v_pk_fma_f32 v[144:145], v[114:115], v[122:123], s[82:83] op_sel:[0,0,0] op_sel_hi:[1,0,1]
    v_pk_fma_f32 v[148:149], v[116:117], v[122:123], s[82:83] op_sel:[0,0,0] op_sel_hi:[1,0,1]
    v_pk_fma_f32 v[152:153], v[118:119], v[122:123], s[82:83] op_sel:[0,0,0] op_sel_hi:[1,0,1]
    v_pk_fma_f32 v[24:25], v[24:25], v[104:105], v[140:141]
    v_pk_fma_f32 v[26:27], v[26:27], v[106:107], v[144:145]
    v_pk_fma_f32 v[28:29], v[28:29], v[108:109], v[148:149]
    v_pk_fma_f32 v[30:31], v[30:31], v[110:111], v[152:153]
    v_pk_mul_f32 v[140:141], v[24:25], s[84:85]
    v_pk_mul_f32 v[144:145], v[26:27], s[84:85]
    v_pk_mul_f32 v[148:149], v[28:29], s[84:85]
    v_pk_mul_f32 v[152:153], v[30:31], s[84:85]
    v_max_f32 v142, s82, v24
    v_max_f32 v146, s82, v26
    v_max_f32 v150, s82, v28
    v_max_f32 v154, s82, v30
    v_exp_f32 v140, v140 clamp
    v_exp_f32 v144, v144 clamp
    v_exp_f32 v148, v148 clamp
    v_exp_f32 v152, v152 clamp
    v_max_f32 v143, s82, v25
    v_max_f32 v147, s82, v27
    v_max_f32 v151, s82, v29
    v_max_f32 v155, s82, v31
    v_exp_f32 v141, v141 clamp
    v_exp_f32 v145, v145 clamp
    v_exp_f32 v149, v149 clamp
    v_exp_f32 v153, v153 clamp
    v_pk_add_f32 v[140:141], v[140:141], v[142:143]
    v_pk_add_f32 v[144:145], v[144:145], v[146:147]
    v_pk_add_f32 v[148:149], v[148:149], v[150:151]
    v_pk_add_f32 v[152:153], v[152:153], v[154:155]
    v_cvt_pk_bf16_f32 v24, v140, v141
    v_cvt_pk_bf16_f32 v25, v144, v145
    v_cvt_pk_bf16_f32 v26, v148, v149
    v_cvt_pk_bf16_f32 v27, v152, v153
    ds_write_b128 v240, v[24:27] offset:4096
    v_pk_fma_f32 v[140:141], v[112:113], v[124:125], s[82:83] op_sel:[0,0,0] op_sel_hi:[1,0,1]
    v_pk_fma_f32 v[144:145], v[114:115], v[124:125], s[82:83] op_sel:[0,0,0] op_sel_hi:[1,0,1]
    v_pk_fma_f32 v[148:149], v[116:117], v[124:125], s[82:83] op_sel:[0,0,0] op_sel_hi:[1,0,1]
    v_pk_fma_f32 v[152:153], v[118:119], v[124:125], s[82:83] op_sel:[0,0,0] op_sel_hi:[1,0,1]
    v_pk_fma_f32 v[32:33], v[32:33], v[104:105], v[140:141]
    v_pk_fma_f32 v[34:35], v[34:35], v[106:107], v[144:145]
    v_pk_fma_f32 v[36:37], v[36:37], v[108:109], v[148:149]
    v_pk_fma_f32 v[38:39], v[38:39], v[110:111], v[152:153]
    v_pk_mul_f32 v[140:141], v[32:33], s[84:85]
    v_pk_mul_f32 v[144:145], v[34:35], s[84:85]
    v_pk_mul_f32 v[148:149], v[36:37], s[84:85]
    v_pk_mul_f32 v[152:153], v[38:39], s[84:85]
    v_max_f32 v142, s82, v32
    v_max_f32 v146, s82, v34
    v_max_f32 v150, s82, v36
    v_max_f32 v154, s82, v38
    v_exp_f32 v140, v140 clamp
    v_exp_f32 v144, v144 clamp
    v_exp_f32 v148, v148 clamp
    v_exp_f32 v152, v152 clamp
    v_max_f32 v143, s82, v33
    v_max_f32 v147, s82, v35
    v_max_f32 v151, s82, v37
    v_max_f32 v155, s82, v39
    v_exp_f32 v141, v141 clamp
    v_exp_f32 v145, v145 clamp
    v_exp_f32 v149, v149 clamp
    v_exp_f32 v153, v153 clamp
    v_pk_add_f32 v[140:141], v[140:141], v[142:143]
    v_pk_add_f32 v[144:145], v[144:145], v[146:147]
    v_pk_add_f32 v[148:149], v[148:149], v[150:151]
    v_pk_add_f32 v[152:153], v[152:153], v[154:155]
    v_cvt_pk_bf16_f32 v32, v140, v141
    v_cvt_pk_bf16_f32 v33, v144, v145
    v_cvt_pk_bf16_f32 v34, v148, v149
    v_cvt_pk_bf16_f32 v35, v152, v153
    ds_write_b128 v240, v[32:35] offset:8192
    v_pk_fma_f32 v[140:141], v[112:113], v[126:127], s[82:83] op_sel:[0,0,0] op_sel_hi:[1,0,1]
    v_pk_fma_f32 v[144:145], v[114:115], v[126:127], s[82:83] op_sel:[0,0,0] op_sel_hi:[1,0,1]
    v_pk_fma_f32 v[148:149], v[116:117], v[126:127], s[82:83] op_sel:[0,0,0] op_sel_hi:[1,0,1]
    v_pk_fma_f32 v[152:153], v[118:119], v[126:127], s[82:83] op_sel:[0,0,0] op_sel_hi:[1,0,1]
    v_pk_fma_f32 v[40:41], v[40:41], v[104:105], v[140:141]
    v_pk_fma_f32 v[42:43], v[42:43], v[106:107], v[144:145]
    v_pk_fma_f32 v[44:45], v[44:45], v[108:109], v[148:149]
    v_pk_fma_f32 v[46:47], v[46:47], v[110:111], v[152:153]
    v_pk_mul_f32 v[140:141], v[40:41], s[84:85]
    v_pk_mul_f32 v[144:145], v[42:43], s[84:85]
    v_pk_mul_f32 v[148:149], v[44:45], s[84:85]
    v_pk_mul_f32 v[152:153], v[46:47], s[84:85]
    v_max_f32 v142, s82, v40
    v_max_f32 v146, s82, v42
    v_max_f32 v150, s82, v44
    v_max_f32 v154, s82, v46
    v_exp_f32 v140, v140 clamp
    v_exp_f32 v144, v144 clamp
    v_exp_f32 v148, v148 clamp
    v_exp_f32 v152, v152 clamp
    v_max_f32 v143, s82, v41
    v_max_f32 v147, s82, v43
    v_max_f32 v151, s82, v45
    v_max_f32 v155, s82, v47
    v_exp_f32 v141, v141 clamp
    v_exp_f32 v145, v145 clamp
    v_exp_f32 v149, v149 clamp
    v_exp_f32 v153, v153 clamp
    v_pk_add_f32 v[140:141], v[140:141], v[142:143]
    v_pk_add_f32 v[144:145], v[144:145], v[146:147]
    v_pk_add_f32 v[148:149], v[148:149], v[150:151]
    v_pk_add_f32 v[152:153], v[152:153], v[154:155]
    v_cvt_pk_bf16_f32 v40, v140, v141
    v_cvt_pk_bf16_f32 v41, v144, v145
    v_cvt_pk_bf16_f32 v42, v148, v149
    v_cvt_pk_bf16_f32 v43, v152, v153
    ds_write_b128 v240, v[40:43] offset:12288
    v_pk_fma_f32 v[140:141], v[112:113], v[128:129], v[246:247] op_sel:[0,0,0] op_sel_hi:[1,0,1]
    v_pk_fma_f32 v[144:145], v[114:115], v[128:129], v[246:247] op_sel:[0,0,0] op_sel_hi:[1,0,1]
    v_pk_fma_f32 v[148:149], v[116:117], v[128:129], v[246:247] op_sel:[0,0,0] op_sel_hi:[1,0,1]
    v_pk_fma_f32 v[152:153], v[118:119], v[128:129], v[246:247] op_sel:[0,0,0] op_sel_hi:[1,0,1]
    v_pk_fma_f32 v[48:49], v[48:49], v[104:105], v[140:141]
    v_pk_fma_f32 v[50:51], v[50:51], v[106:107], v[144:145]
    v_pk_fma_f32 v[52:53], v[52:53], v[108:109], v[148:149]
    v_pk_fma_f32 v[54:55], v[54:55], v[110:111], v[152:153]
    v_pk_mul_f32 v[140:141], v[48:49], s[84:85]
    v_pk_mul_f32 v[144:145], v[50:51], s[84:85]
    v_pk_mul_f32 v[148:149], v[52:53], s[84:85]
    v_pk_mul_f32 v[152:153], v[54:55], s[84:85]
    v_max_f32 v142, s82, v48
    v_max_f32 v146, s82, v50
    v_max_f32 v150, s82, v52
    v_max_f32 v154, s82, v54
    v_exp_f32 v140, v140 clamp
    v_exp_f32 v144, v144 clamp
    v_exp_f32 v148, v148 clamp
    v_exp_f32 v152, v152 clamp
    v_max_f32 v143, s82, v49
    v_max_f32 v147, s82, v51
    v_max_f32 v151, s82, v53
    v_max_f32 v155, s82, v55
    v_exp_f32 v141, v141 clamp
    v_exp_f32 v145, v145 clamp
    v_exp_f32 v149, v149 clamp
    v_exp_f32 v153, v153 clamp
    v_pk_add_f32 v[140:141], v[140:141], v[142:143]
    v_pk_add_f32 v[144:145], v[144:145], v[146:147]
    v_pk_add_f32 v[148:149], v[148:149], v[150:151]
    v_pk_add_f32 v[152:153], v[152:153], v[154:155]
    v_cndmask_b32 v140, v48, v140, s[86:87]
    v_cndmask_b32 v144, v50, v144, s[86:87]
    v_cndmask_b32 v148, v52, v148, s[86:87]
    v_cndmask_b32 v152, v54, v152, s[86:87]
    v_cndmask_b32 v141, v49, v141, s[86:87]
    v_cndmask_b32 v145, v51, v145, s[86:87]
    v_cndmask_b32 v149, v53, v149, s[86:87]
    v_cndmask_b32 v153, v55, v153, s[86:87]
    v_cvt_pk_bf16_f32 v48, v140, v141
    v_cvt_pk_bf16_f32 v49, v144, v145
    v_cvt_pk_bf16_f32 v50, v148, v149
    v_cvt_pk_bf16_f32 v51, v152, v153
    ds_write_b128 v240, v[48:51] offset:16384
    v_pk_mul_f32 v[140:141], v[112:113], v[130:131] op_sel:[0,0] op_sel_hi:[1,0]
    v_pk_mul_f32 v[144:145], v[114:115], v[130:131] op_sel:[0,0] op_sel_hi:[1,0]
    v_pk_mul_f32 v[148:149], v[116:117], v[130:131] op_sel:[0,0] op_sel_hi:[1,0]
    v_pk_mul_f32 v[152:153], v[118:119], v[130:131] op_sel:[0,0] op_sel_hi:[1,0]
    v_pk_fma_f32 v[56:57], v[56:57], v[104:105], v[140:141]
    v_pk_fma_f32 v[58:59], v[58:59], v[106:107], v[144:145]
    v_pk_fma_f32 v[60:61], v[60:61], v[108:109], v[148:149]
    v_pk_fma_f32 v[62:63], v[62:63], v[110:111], v[152:153]
    v_cvt_pk_bf16_f32 v56, v56, v57
    v_cvt_pk_bf16_f32 v57, v58, v59
    v_cvt_pk_bf16_f32 v58, v60, v61
    v_cvt_pk_bf16_f32 v59, v62, v63
    ds_write_b128 v240, v[56:59] offset:20480
    v_pk_mul_f32 v[140:141], v[112:113], v[132:133] op_sel:[0,0] op_sel_hi:[1,0]
    v_pk_mul_f32 v[144:145], v[114:115], v[132:133] op_sel:[0,0] op_sel_hi:[1,0]
    v_pk_mul_f32 v[148:149], v[116:117], v[132:133] op_sel:[0,0] op_sel_hi:[1,0]
    v_pk_mul_f32 v[152:153], v[118:119], v[132:133] op_sel:[0,0] op_sel_hi:[1,0]
    v_pk_fma_f32 v[64:65], v[64:65], v[104:105], v[140:141]
    v_pk_fma_f32 v[66:67], v[66:67], v[106:107], v[144:145]
    v_pk_fma_f32 v[68:69], v[68:69], v[108:109], v[148:149]
    v_pk_fma_f32 v[70:71], v[70:71], v[110:111], v[152:153]
    v_cvt_pk_bf16_f32 v64, v64, v65
    v_cvt_pk_bf16_f32 v65, v66, v67
    v_cvt_pk_bf16_f32 v66, v68, v69
    v_cvt_pk_bf16_f32 v67, v70, v71
    ds_write_b128 v240, v[64:67] offset:24576
    v_pk_mul_f32 v[140:141], v[112:113], v[134:135] op_sel:[0,0] op_sel_hi:[1,0]
    v_pk_mul_f32 v[144:145], v[114:115], v[134:135] op_sel:[0,0] op_sel_hi:[1,0]
    v_pk_mul_f32 v[148:149], v[116:117], v[134:135] op_sel:[0,0] op_sel_hi:[1,0]
    v_pk_mul_f32 v[152:153], v[118:119], v[134:135] op_sel:[0,0] op_sel_hi:[1,0]
    v_pk_fma_f32 v[72:73], v[72:73], v[104:105], v[140:141]
    v_pk_fma_f32 v[74:75], v[74:75], v[106:107], v[144:145]
    v_pk_fma_f32 v[76:77], v[76:77], v[108:109], v[148:149]
    v_pk_fma_f32 v[78:79], v[78:79], v[110:111], v[152:153]
    v_cvt_pk_bf16_f32 v72, v72, v73
    v_cvt_pk_bf16_f32 v73, v74, v75
    v_cvt_pk_bf16_f32 v74, v76, v77
    v_cvt_pk_bf16_f32 v75, v78, v79
    ds_write_b128 v240, v[72:75] offset:28672
    v_pk_mul_f32 v[140:141], v[112:113], v[136:137] op_sel:[0,0] op_sel_hi:[1,0]
    v_pk_mul_f32 v[144:145], v[114:115], v[136:137] op_sel:[0,0] op_sel_hi:[1,0]
    v_pk_mul_f32 v[148:149], v[116:117], v[136:137] op_sel:[0,0] op_sel_hi:[1,0]
    v_pk_mul_f32 v[152:153], v[118:119], v[136:137] op_sel:[0,0] op_sel_hi:[1,0]
    v_pk_fma_f32 v[80:81], v[80:81], v[104:105], v[140:141]
    v_pk_fma_f32 v[82:83], v[82:83], v[106:107], v[144:145]
    v_pk_fma_f32 v[84:85], v[84:85], v[108:109], v[148:149]
    v_pk_fma_f32 v[86:87], v[86:87], v[110:111], v[152:153]
    v_cvt_pk_bf16_f32 v80, v80, v81
    v_cvt_pk_bf16_f32 v81, v82, v83
    v_cvt_pk_bf16_f32 v82, v84, v85
    v_cvt_pk_bf16_f32 v83, v86, v87
    ds_write_b128 v240, v[80:83] offset:32768
    s_mov_b64 exec, 1
    ds_add_u32 v252, v253 offset:12
    s_mov_b64 exec, -1
    s_mov_b32 s38, 1600000
L_cw_9:
    ds_read_b32 v1, v252 offset:12
    s_waitcnt lgkmcnt(0)
    v_readfirstlane_b32 s14, v1
    s_nop 0
    s_cmp_ge_u32 s14, 4
    s_cbranch_scc1 L_cok_10
    s_sub_u32 s38, s38, 1
    s_cbranch_scc0 L_cw_9
L_cok_10:
    s_mov_b64 exec, s[88:89]
    ds_read_b128 v[176:179], v241 offset:0
    ds_read_b128 v[180:183], v241 offset:512
    ds_read_b128 v[184:187], v241 offset:1024
    ds_read_b128 v[188:191], v241 offset:1536
    s_mov_b32 exec_lo, 0x3ffff
    s_mov_b32 exec_hi, 0x3ffff
    ds_read_b128 v[208:211], v242 offset:0
    ds_read_b128 v[212:215], v242 offset:512
    ds_read_b128 v[216:219], v242 offset:1024
    ds_read_b128 v[220:223], v242 offset:1536
    s_mov_b64 exec, s[88:89]
    ds_read_b128 v[192:195], v241 offset:2048
    ds_read_b128 v[196:199], v241 offset:2560
    ds_read_b128 v[200:203], v241 offset:3072
    ds_read_b128 v[204:207], v241 offset:3584
    s_mov_b32 exec_lo, 0x3ffff
    s_mov_b32 exec_hi, 0x3ffff
    ds_read_b128 v[224:227], v242 offset:2048
    ds_read_b128 v[228:231], v242 offset:2560
    ds_read_b128 v[232:235], v242 offset:3072
    s_waitcnt lgkmcnt(11)
    ds_read_b128 v[236:239], v242 offset:3584
    s_mov_b64 exec, -1
    s_waitcnt lgkmcnt(11)
    v_mfma_f32_32x32x16_bf16 v[16:31], v[176:179], v[208:211], 0
    s_waitcnt lgkmcnt(10)
    v_mfma_f32_32x32x16_bf16 v[16:31], v[180:183], v[212:215], v[16:31]
    s_waitcnt lgkmcnt(9)
    v_mfma_f32_32x32x16_bf16 v[16:31], v[184:187], v[216:219], v[16:31]
    s_waitcnt lgkmcnt(8)
    v_mfma_f32_32x32x16_bf16 v[16:31], v[188:191], v[220:223], v[16:31]
    s_waitcnt lgkmcnt(3)
    v_mfma_f32_32x32x16_bf16 v[16:31], v[192:195], v[224:227], v[16:31]
    s_waitcnt lgkmcnt(2)
    v_mfma_f32_32x32x16_bf16 v[16:31], v[196:199], v[228:231], v[16:31]
    s_waitcnt lgkmcnt(1)
    v_mfma_f32_32x32x16_bf16 v[16:31], v[200:203], v[232:235], v[16:31]
    s_waitcnt lgkmcnt(0)
    v_mfma_f32_32x32x16_bf16 v[16:31], v[204:207], v[236:239], v[16:31]
    s_mov_b32 exec_lo, 0xfffff
    s_mov_b32 exec_hi, 0xfffff
    s_nop 9
    v_max_u32 v16, 1, v16
    v_max_u32 v17, 1, v17
    v_max_u32 v18, 1, v18
    v_max_u32 v19, 1, v19
    buffer_store_dwordx4 v[16:19], v243, s[48:51], s90 offen sc1
    v_max_u32 v20, 1, v20
    v_max_u32 v21, 1, v21
    v_max_u32 v22, 1, v22
    v_max_u32 v23, 1, v23
    buffer_store_dwordx4 v[20:23], v244, s[48:51], s90 offen sc1
    v_max_u32 v24, 1, v24
    v_max_u32 v25, 1, v25
    v_max_u32 v26, 1, v26
    v_max_u32 v27, 1, v27
    buffer_store_dwordx4 v[24:27], v245, s[48:51], s90 offen sc1
    s_mov_b64 exec, -1
    s_mov_b64 exec, 1
    ds_add_u32 v252, v253 offset:4
    s_mov_b64 exec, -1
    s_branch L_B_c
    .fill 163, 4, 0xbf810000
L_q:
    s_mov_b32 s82, 0x35c1a2a0
    s_mov_b32 s83, s82
    s_mov_b32 s84, 0x3f317218
    s_mov_b32 s85, s84
    s_mul_i32 s14, s3, 544
    s_add_u32 s14, s14, 159744
    v_lshl_add_u32 v14, v2, 2, s14
    v_lshlrev_b32 v4, 4, v3
    v_add_u32 v15, 160000, v4
    v_add_u32 v248, 800, v15
    v_cmp_gt_u32 vcc, 32, v4
    s_nop 1
    v_cndmask_b32 v249, v248, v15, vcc
    v_add_u32 v248, 320, v248
    v_lshlrev_b32 v240, 4, v0
    v_lshlrev_b32 v241, 7, v0
    s_lshl2_add_u32 s14, s6, s3
    s_lshl2_add_u32 s15, s14, s13
    s_lshl_b32 s91, s15, 7
    s_add_u32 s91, s91, 3440640
    s_mov_b32 s93, s91
    s_mul_i32 s90, s15, 9216
    s_add_u32 s90, s90, 0
    s_mov_b32 s89, s90
    s_waitcnt vmcnt(9)
    s_barrier
    ds_read_b128 v[88:91], v11 offset:0
    ds_read_b128 v[92:95], v11 offset:2048
    ds_read_b64_tr_b16 v[104:105], v13 offset:0
    ds_read_b64_tr_b16 v[106:107], v13 offset:4608
    ds_read_b64_tr_b16 v[108:109], v13 offset:32
    ds_read_b64_tr_b16 v[110:111], v13 offset:4640
    ds_read_b64_tr_b16 v[112:113], v13 offset:64
    ds_read_b64_tr_b16 v[114:115], v13 offset:4672
    ds_read_b64_tr_b16 v[116:117], v13 offset:96
    ds_read_b64_tr_b16 v[118:119], v13 offset:4704
    ds_read_b64_tr_b16 v[120:121], v13 offset:128
    ds_read_b64_tr_b16 v[122:123], v13 offset:4736
    ds_read_b64_tr_b16 v[124:125], v13 offset:160
    ds_read_b64_tr_b16 v[126:127], v13 offset:4768
L_qloop:
    s_waitcnt lgkmcnt(10)
    v_mfma_f32_16x16x32_bf16 v[16:19], v[104:107], v[88:91], v[16:19]
    ds_read_b64_tr_b16 v[128:129], v13 offset:192
    ds_read_b64_tr_b16 v[130:131], v13 offset:4800
    ds_read_b64_tr_b16 v[132:133], v13 offset:224
    ds_read_b64_tr_b16 v[134:135], v13 offset:4832
    v_mfma_f32_16x16x32_bf16 v[20:23], v[104:107], v[92:95], v[20:23]
    s_waitcnt lgkmcnt(12)
    v_mfma_f32_16x16x32_bf16 v[24:27], v[108:111], v[88:91], v[24:27]
    ds_read_b64_tr_b16 v[136:137], v13 offset:256
    ds_read_b64_tr_b16 v[138:139], v13 offset:4864
    v_mfma_f32_16x16x32_bf16 v[28:31], v[108:111], v[92:95], v[28:31]
    s_waitcnt lgkmcnt(12)
    v_mfma_f32_16x16x32_bf16 v[32:35], v[112:115], v[88:91], v[32:35]
    ds_read_b128 v[96:99], v12 offset:0
    ds_read_b128 v[100:103], v12 offset:2048
    v_mfma_f32_16x16x32_bf16 v[36:39], v[112:115], v[92:95], v[36:39]
    s_waitcnt lgkmcnt(12)
    v_mfma_f32_16x16x32_bf16 v[40:43], v[116:119], v[88:91], v[40:43]
    ds_read_b64_tr_b16 v[140:141], v13 offset:9216
    ds_read_b64_tr_b16 v[142:143], v13 offset:13824
    v_mfma_f32_16x16x32_bf16 v[44:47], v[116:119], v[92:95], v[44:47]
    s_waitcnt lgkmcnt(12)
    v_mfma_f32_16x16x32_bf16 v[48:51], v[120:123], v[88:91], v[48:51]
    ds_read_b64_tr_b16 v[144:145], v13 offset:9248
    ds_read_b64_tr_b16 v[146:147], v13 offset:13856
    v_mfma_f32_16x16x32_bf16 v[52:55], v[120:123], v[92:95], v[52:55]
    s_waitcnt lgkmcnt(12)
    v_mfma_f32_16x16x32_bf16 v[56:59], v[124:127], v[88:91], v[56:59]
    ds_read_b64_tr_b16 v[148:149], v13 offset:9280
    ds_read_b64_tr_b16 v[150:151], v13 offset:13888
    v_mfma_f32_16x16x32_bf16 v[60:63], v[124:127], v[92:95], v[60:63]
    s_waitcnt lgkmcnt(12)
    v_mfma_f32_16x16x32_bf16 v[64:67], v[128:131], v[88:91], v[64:67]
    ds_read_b64_tr_b16 v[152:153], v13 offset:9312
    ds_read_b64_tr_b16 v[154:155], v13 offset:13920
    v_mfma_f32_16x16x32_bf16 v[68:71], v[128:131], v[92:95], v[68:71]
    s_waitcnt lgkmcnt(12)
    v_mfma_f32_16x16x32_bf16 v[72:75], v[132:135], v[88:91], v[72:75]
    ds_read_b64_tr_b16 v[156:157], v13 offset:9344
    ds_read_b64_tr_b16 v[158:159], v13 offset:13952
    v_mfma_f32_16x16x32_bf16 v[76:79], v[132:135], v[92:95], v[76:79]
    s_waitcnt lgkmcnt(12)
    v_mfma_f32_16x16x32_bf16 v[80:83], v[136:139], v[88:91], v[80:83]
    ds_read_b64_tr_b16 v[160:161], v13 offset:9376
    ds_read_b64_tr_b16 v[162:163], v13 offset:13984
    v_mfma_f32_16x16x32_bf16 v[84:87], v[136:139], v[92:95], v[84:87]
    s_waitcnt lgkmcnt(10)
    v_mfma_f32_16x16x32_bf16 v[16:19], v[140:143], v[96:99], v[16:19]
    ds_read_b64_tr_b16 v[164:165], v13 offset:9408
    ds_read_b64_tr_b16 v[166:167], v13 offset:14016
    ds_read_b64_tr_b16 v[168:169], v13 offset:9440
    ds_read_b64_tr_b16 v[170:171], v13 offset:14048
    v_mfma_f32_16x16x32_bf16 v[20:23], v[140:143], v[100:103], v[20:23]
    s_waitcnt lgkmcnt(12)
    v_mfma_f32_16x16x32_bf16 v[24:27], v[144:147], v[96:99], v[24:27]
    ds_read_b64_tr_b16 v[172:173], v13 offset:9472
    ds_read_b64_tr_b16 v[174:175], v13 offset:14080
    v_mfma_f32_16x16x32_bf16 v[28:31], v[144:147], v[100:103], v[28:31]
    s_waitcnt lgkmcnt(12)
    v_mfma_f32_16x16x32_bf16 v[32:35], v[148:151], v[96:99], v[32:35]
    v_mfma_f32_16x16x32_bf16 v[36:39], v[148:151], v[100:103], v[36:39]
    s_waitcnt lgkmcnt(10)
    v_mfma_f32_16x16x32_bf16 v[40:43], v[152:155], v[96:99], v[40:43]
    s_add_u32 s80, s80, 36864
    s_cmp_eq_u32 s80, 147456
    s_cselect_b32 s80, 0, s80
    s_sub_u32 s81, s81, 1
    v_mfma_f32_16x16x32_bf16 v[44:47], v[152:155], v[100:103], v[44:47]
    v_add_u32 v11, s80, v8
    v_add_u32 v13, s80, v10
    v_add_u32 v12, s80, v9
    s_cmp_eq_u32 s81, 0
    s_waitcnt vmcnt(0) lgkmcnt(0)
    s_barrier
    s_cbranch_scc1 L_qloop_tail
    ds_read_b128 v[88:91], v11 offset:0
    ds_read_b128 v[92:95], v11 offset:2048
    v_mfma_f32_16x16x32_bf16 v[48:51], v[156:159], v[96:99], v[48:51]
    ds_read_b64_tr_b16 v[104:105], v13 offset:0
    ds_read_b64_tr_b16 v[106:107], v13 offset:4608
    v_mfma_f32_16x16x32_bf16 v[52:55], v[156:159], v[100:103], v[52:55]
    ds_read_b64_tr_b16 v[108:109], v13 offset:32
    ds_read_b64_tr_b16 v[110:111], v13 offset:4640
    v_mfma_f32_16x16x32_bf16 v[56:59], v[160:163], v[96:99], v[56:59]
    ds_read_b64_tr_b16 v[112:113], v13 offset:64
    ds_read_b64_tr_b16 v[114:115], v13 offset:4672
    v_mfma_f32_16x16x32_bf16 v[60:63], v[160:163], v[100:103], v[60:63]
    ds_read_b64_tr_b16 v[116:117], v13 offset:96
    ds_read_b64_tr_b16 v[118:119], v13 offset:4704
    v_mfma_f32_16x16x32_bf16 v[64:67], v[164:167], v[96:99], v[64:67]
    ds_read_b64_tr_b16 v[120:121], v13 offset:128
    ds_read_b64_tr_b16 v[122:123], v13 offset:4736
    v_mfma_f32_16x16x32_bf16 v[68:71], v[164:167], v[100:103], v[68:71]
    ds_read_b64_tr_b16 v[124:125], v13 offset:160
    ds_read_b64_tr_b16 v[126:127], v13 offset:4768
    v_mfma_f32_16x16x32_bf16 v[72:75], v[168:171], v[96:99], v[72:75]
    v_mfma_f32_16x16x32_bf16 v[76:79], v[168:171], v[100:103], v[76:79]
    v_mfma_f32_16x16x32_bf16 v[80:83], v[172:175], v[96:99], v[80:83]
    v_mfma_f32_16x16x32_bf16 v[84:87], v[172:175], v[100:103], v[84:87]
    s_branch L_qloop
L_qloop_tail:
    ds_read_b32 v88, v14 offset:0
    ds_read_b32 v90, v14 offset:128
    ds_read_b32 v89, v14 offset:64
    ds_read_b32 v91, v14 offset:192
    ds_read_b128 v[104:107], v15 offset:0
    ds_read_b128 v[176:179], v15 offset:544
    ds_read_b128 v[108:111], v15 offset:64
    ds_read_b128 v[180:183], v15 offset:608
    ds_read_b128 v[112:115], v15 offset:128
    ds_read_b128 v[184:187], v15 offset:672
    ds_read_b128 v[116:119], v15 offset:192
    ds_read_b128 v[188:191], v15 offset:736
    ds_read_b128 v[120:123], v249 offset:256
    s_waitcnt lgkmcnt(4)
    ds_read_b128 v[192:195], v249 offset:800
    ds_read_b128 v[124:127], v248 offset:0
    ds_read_b128 v[196:199], v248 offset:544
    ds_read_b128 v[128:131], v248 offset:64
    ds_read_b128 v[200:203], v248 offset:608
    ds_read_b128 v[132:135], v248 offset:128
    ds_read_b128 v[204:207], v248 offset:672
    ds_read_b128 v[136:139], v248 offset:192
    ds_read_b128 v[208:211], v248 offset:736
    v_mfma_f32_16x16x32_bf16 v[48:51], v[156:159], v[96:99], v[48:51]
    v_mfma_f32_16x16x32_bf16 v[52:55], v[156:159], v[100:103], v[52:55]
    v_mfma_f32_16x16x32_bf16 v[56:59], v[160:163], v[96:99], v[56:59]
    v_mfma_f32_16x16x32_bf16 v[60:63], v[160:163], v[100:103], v[60:63]
    v_mfma_f32_16x16x32_bf16 v[64:67], v[164:167], v[96:99], v[64:67]
    v_mfma_f32_16x16x32_bf16 v[68:71], v[164:167], v[100:103], v[68:71]
    v_mfma_f32_16x16x32_bf16 v[72:75], v[168:171], v[96:99], v[72:75]
    v_mfma_f32_16x16x32_bf16 v[76:79], v[168:171], v[100:103], v[76:79]
    v_mfma_f32_16x16x32_bf16 v[80:83], v[172:175], v[96:99], v[80:83]
    v_mfma_f32_16x16x32_bf16 v[84:87], v[172:175], v[100:103], v[84:87]
    s_waitcnt lgkmcnt(0)
    v_mul_f32 v88, 0x3fb8aa3b, v88
    v_mul_f32 v89, 0x3fb8aa3b, v89
    v_mul_f32 v90, 0x3fb8aa3b, v90
    v_mul_f32 v91, 0x3fb8aa3b, v91
    v_pk_add_f32 v[104:105], v[104:105], v[176:177]
    v_pk_add_f32 v[106:107], v[106:107], v[178:179]
    v_pk_add_f32 v[108:109], v[108:109], v[180:181]
    v_pk_add_f32 v[110:111], v[110:111], v[182:183]
    v_pk_add_f32 v[112:113], v[112:113], v[184:185]
    v_pk_add_f32 v[114:115], v[114:115], v[186:187]
    v_pk_add_f32 v[116:117], v[116:117], v[188:189]
    v_pk_add_f32 v[118:119], v[118:119], v[190:191]
    v_pk_add_f32 v[120:121], v[120:121], v[192:193]
    v_pk_add_f32 v[122:123], v[122:123], v[194:195]
    v_pk_add_f32 v[124:125], v[124:125], v[196:197]
    v_pk_add_f32 v[126:127], v[126:127], v[198:199]
    v_pk_add_f32 v[128:129], v[128:129], v[200:201]
    v_pk_add_f32 v[130:131], v[130:131], v[202:203]
    v_pk_add_f32 v[132:133], v[132:133], v[204:205]
    v_pk_add_f32 v[134:135], v[134:135], v[206:207]
    v_pk_add_f32 v[136:137], v[136:137], v[208:209]
    v_pk_add_f32 v[138:139], v[138:139], v[210:211]
    v_pk_fma_f32 v[140:141], v[104:105], v[90:91], s[82:83] op_sel:[0,0,0] op_sel_hi:[1,0,1]
    v_pk_fma_f32 v[144:145], v[106:107], v[90:91], s[82:83] op_sel:[0,0,0] op_sel_hi:[1,0,1]
    v_pk_fma_f32 v[148:149], v[104:105], v[90:91], s[82:83] op_sel:[0,1,0] op_sel_hi:[1,1,1]
    v_pk_fma_f32 v[152:153], v[106:107], v[90:91], s[82:83] op_sel:[0,1,0] op_sel_hi:[1,1,1]
    v_pk_fma_f32 v[16:17], v[16:17], v[88:89], v[140:141] op_sel:[0,0,0] op_sel_hi:[1,0,1]
    v_pk_fma_f32 v[18:19], v[18:19], v[88:89], v[144:145] op_sel:[0,0,0] op_sel_hi:[1,0,1]
    v_pk_fma_f32 v[20:21], v[20:21], v[88:89], v[148:149] op_sel:[0,1,0] op_sel_hi:[1,1,1]
    v_pk_fma_f32 v[22:23], v[22:23], v[88:89], v[152:153] op_sel:[0,1,0] op_sel_hi:[1,1,1]
    v_exp_f32 v140, v16 clamp
    v_exp_f32 v144, v18 clamp
    v_exp_f32 v148, v20 clamp
    v_exp_f32 v152, v22 clamp
    v_max_f32 v142, s82, v16
    v_max_f32 v146, s82, v18
    v_max_f32 v150, s82, v20
    v_max_f32 v154, s82, v22
    v_exp_f32 v141, v17 clamp
    v_exp_f32 v145, v19 clamp
    v_exp_f32 v149, v21 clamp
    v_exp_f32 v153, v23 clamp
    v_max_f32 v143, s82, v17
    v_max_f32 v147, s82, v19
    v_max_f32 v151, s82, v21
    v_max_f32 v155, s82, v23
    v_pk_fma_f32 v[140:141], v[142:143], s[84:85], v[140:141]
    v_pk_fma_f32 v[144:145], v[146:147], s[84:85], v[144:145]
    v_pk_fma_f32 v[148:149], v[150:151], s[84:85], v[148:149]
    v_pk_fma_f32 v[152:153], v[154:155], s[84:85], v[152:153]
    v_cvt_pk_bf16_f32 v176, v140, v141
    v_cvt_pk_bf16_f32 v177, v144, v145
    v_cvt_pk_bf16_f32 v178, v148, v149
    v_cvt_pk_bf16_f32 v179, v152, v153
    v_pk_fma_f32 v[140:141], v[108:109], v[90:91], s[82:83] op_sel:[0,0,0] op_sel_hi:[1,0,1]
    v_pk_fma_f32 v[144:145], v[110:111], v[90:91], s[82:83] op_sel:[0,0,0] op_sel_hi:[1,0,1]
    v_pk_fma_f32 v[148:149], v[108:109], v[90:91], s[82:83] op_sel:[0,1,0] op_sel_hi:[1,1,1]
    v_pk_fma_f32 v[152:153], v[110:111], v[90:91], s[82:83] op_sel:[0,1,0] op_sel_hi:[1,1,1]
    v_permlane16_swap_b32 v176, v178
    v_pk_fma_f32 v[24:25], v[24:25], v[88:89], v[140:141] op_sel:[0,0,0] op_sel_hi:[1,0,1]
    v_pk_fma_f32 v[26:27], v[26:27], v[88:89], v[144:145] op_sel:[0,0,0] op_sel_hi:[1,0,1]
    v_pk_fma_f32 v[28:29], v[28:29], v[88:89], v[148:149] op_sel:[0,1,0] op_sel_hi:[1,1,1]
    v_pk_fma_f32 v[30:31], v[30:31], v[88:89], v[152:153] op_sel:[0,1,0] op_sel_hi:[1,1,1]
    v_permlane16_swap_b32 v177, v179
    v_exp_f32 v140, v24 clamp
    v_exp_f32 v144, v26 clamp
    v_exp_f32 v148, v28 clamp
    v_exp_f32 v152, v30 clamp
    buffer_store_dwordx4 v[176:179], v240, s[48:51], s90 offen offset:0 sc1
    v_max_f32 v142, s82, v24
    v_max_f32 v146, s82, v26
    v_max_f32 v150, s82, v28
    v_max_f32 v154, s82, v30
    v_exp_f32 v141, v25 clamp
    v_exp_f32 v145, v27 clamp
    v_exp_f32 v149, v29 clamp
    v_exp_f32 v153, v31 clamp
    v_max_f32 v143, s82, v25
    v_max_f32 v147, s82, v27
    v_max_f32 v151, s82, v29
    v_max_f32 v155, s82, v31
    v_pk_fma_f32 v[140:141], v[142:143], s[84:85], v[140:141]
    v_pk_fma_f32 v[144:145], v[146:147], s[84:85], v[144:145]
    v_pk_fma_f32 v[148:149], v[150:151], s[84:85], v[148:149]
    v_pk_fma_f32 v[152:153], v[154:155], s[84:85], v[152:153]
    v_cvt_pk_bf16_f32 v180, v140, v141
    v_cvt_pk_bf16_f32 v181, v144, v145
    v_cvt_pk_bf16_f32 v182, v148, v149
    v_cvt_pk_bf16_f32 v183, v152, v153
    v_pk_fma_f32 v[140:141], v[112:113], v[90:91], s[82:83] op_sel:[0,0,0] op_sel_hi:[1,0,1]
    v_pk_fma_f32 v[144:145], v[114:115], v[90:91], s[82:83] op_sel:[0,0,0] op_sel_hi:[1,0,1]
    v_pk_fma_f32 v[148:149], v[112:113], v[90:91], s[82:83] op_sel:[0,1,0] op_sel_hi:[1,1,1]
    v_pk_fma_f32 v[152:153], v[114:115], v[90:91], s[82:83] op_sel:[0,1,0] op_sel_hi:[1,1,1]
    v_permlane16_swap_b32 v180, v182
    v_pk_fma_f32 v[32:33], v[32:33], v[88:89], v[140:141] op_sel:[0,0,0] op_sel_hi:[1,0,1]
    v_pk_fma_f32 v[34:35], v[34:35], v[88:89], v[144:145] op_sel:[0,0,0] op_sel_hi:[1,0,1]
    v_pk_fma_f32 v[36:37], v[36:37], v[88:89], v[148:149] op_sel:[0,1,0] op_sel_hi:[1,1,1]
    v_pk_fma_f32 v[38:39], v[38:39], v[88:89], v[152:153] op_sel:[0,1,0] op_sel_hi:[1,1,1]
    v_permlane16_swap_b32 v181, v183
    v_exp_f32 v140, v32 clamp
    v_exp_f32 v144, v34 clamp
    v_exp_f32 v148, v36 clamp
    v_exp_f32 v152, v38 clamp
    buffer_store_dwordx4 v[180:183], v240, s[48:51], s90 offen offset:1024 sc1
    v_max_f32 v142, s82, v32
    v_max_f32 v146, s82, v34
    v_max_f32 v150, s82, v36
    v_max_f32 v154, s82, v38
    v_exp_f32 v141, v33 clamp
    v_exp_f32 v145, v35 clamp
    v_exp_f32 v149, v37 clamp
    v_exp_f32 v153, v39 clamp
    v_max_f32 v143, s82, v33
    v_max_f32 v147, s82, v35
    v_max_f32 v151, s82, v37
    v_max_f32 v155, s82, v39
    v_pk_fma_f32 v[140:141], v[142:143], s[84:85], v[140:141]
    v_pk_fma_f32 v[144:145], v[146:147], s[84:85], v[144:145]
    v_pk_fma_f32 v[148:149], v[150:151], s[84:85], v[148:149]
    v_pk_fma_f32 v[152:153], v[154:155], s[84:85], v[152:153]
    v_cvt_pk_bf16_f32 v184, v140, v141
    v_cvt_pk_bf16_f32 v185, v144, v145
    v_cvt_pk_bf16_f32 v186, v148, v149
    v_cvt_pk_bf16_f32 v187, v152, v153
    v_pk_fma_f32 v[140:141], v[116:117], v[90:91], s[82:83] op_sel:[0,0,0] op_sel_hi:[1,0,1]
    v_pk_fma_f32 v[144:145], v[118:119], v[90:91], s[82:83] op_sel:[0,0,0] op_sel_hi:[1,0,1]
    v_pk_fma_f32 v[148:149], v[116:117], v[90:91], s[82:83] op_sel:[0,1,0] op_sel_hi:[1,1,1]
    v_pk_fma_f32 v[152:153], v[118:119], v[90:91], s[82:83] op_sel:[0,1,0] op_sel_hi:[1,1,1]
    v_permlane16_swap_b32 v184, v186
    v_pk_fma_f32 v[40:41], v[40:41], v[88:89], v[140:141] op_sel:[0,0,0] op_sel_hi:[1,0,1]
    v_pk_fma_f32 v[42:43], v[42:43], v[88:89], v[144:145] op_sel:[0,0,0] op_sel_hi:[1,0,1]
    v_pk_fma_f32 v[44:45], v[44:45], v[88:89], v[148:149] op_sel:[0,1,0] op_sel_hi:[1,1,1]
    v_pk_fma_f32 v[46:47], v[46:47], v[88:89], v[152:153] op_sel:[0,1,0] op_sel_hi:[1,1,1]
    v_permlane16_swap_b32 v185, v187
    v_exp_f32 v140, v40 clamp
    v_exp_f32 v144, v42 clamp
    v_exp_f32 v148, v44 clamp
    v_exp_f32 v152, v46 clamp
    buffer_store_dwordx4 v[184:187], v240, s[48:51], s90 offen offset:2048 sc1
    v_max_f32 v142, s82, v40
    v_max_f32 v146, s82, v42
    v_max_f32 v150, s82, v44
    v_max_f32 v154, s82, v46
    v_exp_f32 v141, v41 clamp
    v_exp_f32 v145, v43 clamp
    v_exp_f32 v149, v45 clamp
    v_exp_f32 v153, v47 clamp
    v_max_f32 v143, s82, v41
    v_max_f32 v147, s82, v43
    v_max_f32 v151, s82, v45
    v_max_f32 v155, s82, v47
    v_pk_fma_f32 v[140:141], v[142:143], s[84:85], v[140:141]
    v_pk_fma_f32 v[144:145], v[146:147], s[84:85], v[144:145]
    v_pk_fma_f32 v[148:149], v[150:151], s[84:85], v[148:149]
    v_pk_fma_f32 v[152:153], v[154:155], s[84:85], v[152:153]
    v_cvt_pk_bf16_f32 v188, v140, v141
    v_cvt_pk_bf16_f32 v189, v144, v145
    v_cvt_pk_bf16_f32 v190, v148, v149
    v_cvt_pk_bf16_f32 v191, v152, v153
    v_pk_fma_f32 v[140:141], v[120:121], v[90:91], s[82:83] op_sel:[0,0,0] op_sel_hi:[1,0,1]
    v_pk_fma_f32 v[144:145], v[122:123], v[90:91], s[82:83] op_sel:[0,0,0] op_sel_hi:[1,0,1]
    v_pk_fma_f32 v[148:149], v[120:121], v[90:91], s[82:83] op_sel:[0,1,0] op_sel_hi:[1,1,1]
    v_pk_fma_f32 v[152:153], v[122:123], v[90:91], s[82:83] op_sel:[0,1,0] op_sel_hi:[1,1,1]
    v_permlane16_swap_b32 v188, v190
    v_pk_fma_f32 v[48:49], v[48:49], v[88:89], v[140:141] op_sel:[0,0,0] op_sel_hi:[1,0,1]
    v_pk_fma_f32 v[50:51], v[50:51], v[88:89], v[144:145] op_sel:[0,0,0] op_sel_hi:[1,0,1]
    v_pk_fma_f32 v[52:53], v[52:53], v[88:89], v[148:149] op_sel:[0,1,0] op_sel_hi:[1,1,1]
    v_pk_fma_f32 v[54:55], v[54:55], v[88:89], v[152:153] op_sel:[0,1,0] op_sel_hi:[1,1,1]
    v_permlane16_swap_b32 v189, v191
    v_exp_f32 v140, v48 clamp
    v_exp_f32 v144, v50 clamp
    v_exp_f32 v148, v52 clamp
    v_exp_f32 v152, v54 clamp
    buffer_store_dwordx4 v[188:191], v240, s[48:51], s90 offen offset:3072 sc1
    v_max_f32 v142, s82, v48
    v_max_f32 v146, s82, v50
    v_max_f32 v150, s82, v52
    v_max_f32 v154, s82, v54
    v_exp_f32 v141, v49 clamp
    v_exp_f32 v145, v51 clamp
    v_exp_f32 v149, v53 clamp
    v_exp_f32 v153, v55 clamp
    v_max_f32 v143, s82, v49
    v_max_f32 v147, s82, v51
    v_max_f32 v151, s82, v53
    v_max_f32 v155, s82, v55
    v_pk_fma_f32 v[140:141], v[142:143], s[84:85], v[140:141]
    v_pk_fma_f32 v[144:145], v[146:147], s[84:85], v[144:145]
    v_pk_fma_f32 v[148:149], v[150:151], s[84:85], v[148:149]
    v_pk_fma_f32 v[152:153], v[154:155], s[84:85], v[152:153]
    v_cvt_pk_bf16_f32 v192, v140, v141
    v_cvt_pk_bf16_f32 v193, v144, v145
    v_cvt_pk_bf16_f32 v194, v148, v149
    v_cvt_pk_bf16_f32 v195, v152, v153
    v_pk_fma_f32 v[140:141], v[124:125], v[90:91], s[82:83] op_sel:[0,0,0] op_sel_hi:[1,0,1]
    v_pk_fma_f32 v[144:145], v[126:127], v[90:91], s[82:83] op_sel:[0,0,0] op_sel_hi:[1,0,1]
    v_pk_fma_f32 v[148:149], v[124:125], v[90:91], s[82:83] op_sel:[0,1,0] op_sel_hi:[1,1,1]
    v_pk_fma_f32 v[152:153], v[126:127], v[90:91], s[82:83] op_sel:[0,1,0] op_sel_hi:[1,1,1]
    v_permlane16_swap_b32 v192, v194
    v_pk_fma_f32 v[56:57], v[56:57], v[88:89], v[140:141] op_sel:[0,0,0] op_sel_hi:[1,0,1]
    v_pk_fma_f32 v[58:59], v[58:59], v[88:89], v[144:145] op_sel:[0,0,0] op_sel_hi:[1,0,1]
    v_pk_fma_f32 v[60:61], v[60:61], v[88:89], v[148:149] op_sel:[0,1,0] op_sel_hi:[1,1,1]
    v_pk_fma_f32 v[62:63], v[62:63], v[88:89], v[152:153] op_sel:[0,1,0] op_sel_hi:[1,1,1]
    v_permlane16_swap_b32 v193, v195
    v_exp_f32 v140, v56 clamp
    v_exp_f32 v144, v58 clamp
    v_exp_f32 v148, v60 clamp
    v_exp_f32 v152, v62 clamp
    s_add_u32 s90, s90, 4096
    v_max_f32 v142, s82, v56
    v_max_f32 v146, s82, v58
    v_max_f32 v150, s82, v60
    v_max_f32 v154, s82, v62
    buffer_store_dwordx4 v[192:195], v240, s[48:51], s90 offen offset:0 sc1
    v_exp_f32 v141, v57 clamp
    v_exp_f32 v145, v59 clamp
    v_exp_f32 v149, v61 clamp
    v_exp_f32 v153, v63 clamp
    v_max_f32 v143, s82, v57
    v_max_f32 v147, s82, v59
    v_max_f32 v151, s82, v61
    v_max_f32 v155, s82, v63
    v_pk_fma_f32 v[140:141], v[142:143], s[84:85], v[140:141]
    v_pk_fma_f32 v[144:145], v[146:147], s[84:85], v[144:145]
    v_pk_fma_f32 v[148:149], v[150:151], s[84:85], v[148:149]
    v_pk_fma_f32 v[152:153], v[154:155], s[84:85], v[152:153]
    v_cvt_pk_bf16_f32 v196, v140, v141
    v_cvt_pk_bf16_f32 v197, v144, v145
    v_cvt_pk_bf16_f32 v198, v148, v149
    v_cvt_pk_bf16_f32 v199, v152, v153
    v_pk_fma_f32 v[140:141], v[128:129], v[90:91], s[82:83] op_sel:[0,0,0] op_sel_hi:[1,0,1]
    v_pk_fma_f32 v[144:145], v[130:131], v[90:91], s[82:83] op_sel:[0,0,0] op_sel_hi:[1,0,1]
    v_pk_fma_f32 v[148:149], v[128:129], v[90:91], s[82:83] op_sel:[0,1,0] op_sel_hi:[1,1,1]
    v_pk_fma_f32 v[152:153], v[130:131], v[90:91], s[82:83] op_sel:[0,1,0] op_sel_hi:[1,1,1]
    v_permlane16_swap_b32 v196, v198
    v_pk_fma_f32 v[64:65], v[64:65], v[88:89], v[140:141] op_sel:[0,0,0] op_sel_hi:[1,0,1]
    v_pk_fma_f32 v[66:67], v[66:67], v[88:89], v[144:145] op_sel:[0,0,0] op_sel_hi:[1,0,1]
    v_pk_fma_f32 v[68:69], v[68:69], v[88:89], v[148:149] op_sel:[0,1,0] op_sel_hi:[1,1,1]
    v_pk_fma_f32 v[70:71], v[70:71], v[88:89], v[152:153] op_sel:[0,1,0] op_sel_hi:[1,1,1]
    v_permlane16_swap_b32 v197, v199
    v_exp_f32 v140, v64 clamp
    v_exp_f32 v144, v66 clamp
    v_exp_f32 v148, v68 clamp
    v_exp_f32 v152, v70 clamp
    buffer_store_dwordx4 v[196:199], v240, s[48:51], s90 offen offset:1024 sc1
    v_max_f32 v142, s82, v64
    v_max_f32 v146, s82, v66
    v_max_f32 v150, s82, v68
    v_max_f32 v154, s82, v70
    v_exp_f32 v141, v65 clamp
    v_exp_f32 v145, v67 clamp
    v_exp_f32 v149, v69 clamp
    v_exp_f32 v153, v71 clamp
    v_max_f32 v143, s82, v65
    v_max_f32 v147, s82, v67
    v_max_f32 v151, s82, v69
    v_max_f32 v155, s82, v71
    v_pk_fma_f32 v[140:141], v[142:143], s[84:85], v[140:141]
    v_pk_fma_f32 v[144:145], v[146:147], s[84:85], v[144:145]
    v_pk_fma_f32 v[148:149], v[150:151], s[84:85], v[148:149]
    v_pk_fma_f32 v[152:153], v[154:155], s[84:85], v[152:153]
    v_cvt_pk_bf16_f32 v200, v140, v141
    v_cvt_pk_bf16_f32 v201, v144, v145
    v_cvt_pk_bf16_f32 v202, v148, v149
    v_cvt_pk_bf16_f32 v203, v152, v153
    v_pk_fma_f32 v[140:141], v[132:133], v[90:91], s[82:83] op_sel:[0,0,0] op_sel_hi:[1,0,1]
    v_pk_fma_f32 v[144:145], v[134:135], v[90:91], s[82:83] op_sel:[0,0,0] op_sel_hi:[1,0,1]
    v_pk_fma_f32 v[148:149], v[132:133], v[90:91], s[82:83] op_sel:[0,1,0] op_sel_hi:[1,1,1]
    v_pk_fma_f32 v[152:153], v[134:135], v[90:91], s[82:83] op_sel:[0,1,0] op_sel_hi:[1,1,1]
    v_permlane16_swap_b32 v200, v202
    v_pk_fma_f32 v[72:73], v[72:73], v[88:89], v[140:141] op_sel:[0,0,0] op_sel_hi:[1,0,1]
    v_pk_fma_f32 v[74:75], v[74:75], v[88:89], v[144:145] op_sel:[0,0,0] op_sel_hi:[1,0,1]
    v_pk_fma_f32 v[76:77], v[76:77], v[88:89], v[148:149] op_sel:[0,1,0] op_sel_hi:[1,1,1]
    v_pk_fma_f32 v[78:79], v[78:79], v[88:89], v[152:153] op_sel:[0,1,0] op_sel_hi:[1,1,1]
    v_permlane16_swap_b32 v201, v203
    v_exp_f32 v140, v72 clamp
    v_exp_f32 v144, v74 clamp
    v_exp_f32 v148, v76 clamp
    v_exp_f32 v152, v78 clamp
    buffer_store_dwordx4 v[200:203], v240, s[48:51], s90 offen offset:2048 sc1
    v_max_f32 v142, s82, v72
    v_max_f32 v146, s82, v74
    v_max_f32 v150, s82, v76
    v_max_f32 v154, s82, v78
    s_waitcnt vmcnt(3)
    s_mov_b32 exec_hi, 0
    buffer_load_dword v242, v241, s[48:51], s89 offen sc1
    s_mov_b64 exec, -1
    v_exp_f32 v141, v73 clamp
    v_exp_f32 v145, v75 clamp
    v_exp_f32 v149, v77 clamp
    v_exp_f32 v153, v79 clamp
    v_max_f32 v143, s82, v73
    v_max_f32 v147, s82, v75
    v_max_f32 v151, s82, v77
    v_max_f32 v155, s82, v79
    v_pk_fma_f32 v[140:141], v[142:143], s[84:85], v[140:141]
    v_pk_fma_f32 v[144:145], v[146:147], s[84:85], v[144:145]
    v_pk_fma_f32 v[148:149], v[150:151], s[84:85], v[148:149]
    v_pk_fma_f32 v[152:153], v[154:155], s[84:85], v[152:153]
    v_cvt_pk_bf16_f32 v204, v140, v141
    v_cvt_pk_bf16_f32 v205, v144, v145
    v_cvt_pk_bf16_f32 v206, v148, v149
    v_cvt_pk_bf16_f32 v207, v152, v153
    v_pk_fma_f32 v[140:141], v[136:137], v[90:91], s[82:83] op_sel:[0,0,0] op_sel_hi:[1,0,1]
    v_pk_fma_f32 v[144:145], v[138:139], v[90:91], s[82:83] op_sel:[0,0,0] op_sel_hi:[1,0,1]
    v_pk_fma_f32 v[148:149], v[136:137], v[90:91], s[82:83] op_sel:[0,1,0] op_sel_hi:[1,1,1]
    v_pk_fma_f32 v[152:153], v[138:139], v[90:91], s[82:83] op_sel:[0,1,0] op_sel_hi:[1,1,1]
    v_permlane16_swap_b32 v204, v206
    v_pk_fma_f32 v[80:81], v[80:81], v[88:89], v[140:141] op_sel:[0,0,0] op_sel_hi:[1,0,1]
    v_pk_fma_f32 v[82:83], v[82:83], v[88:89], v[144:145] op_sel:[0,0,0] op_sel_hi:[1,0,1]
    v_pk_fma_f32 v[84:85], v[84:85], v[88:89], v[148:149] op_sel:[0,1,0] op_sel_hi:[1,1,1]
    v_pk_fma_f32 v[86:87], v[86:87], v[88:89], v[152:153] op_sel:[0,1,0] op_sel_hi:[1,1,1]
    v_permlane16_swap_b32 v205, v207
    v_exp_f32 v140, v80 clamp
    v_exp_f32 v144, v82 clamp
    v_exp_f32 v148, v84 clamp
    v_exp_f32 v152, v86 clamp
    buffer_store_dwordx4 v[204:207], v240, s[48:51], s90 offen offset:3072 sc1
    v_max_f32 v142, s82, v80
    v_max_f32 v146, s82, v82
    v_max_f32 v150, s82, v84
    v_max_f32 v154, s82, v86
    v_exp_f32 v141, v81 clamp
    v_exp_f32 v145, v83 clamp
    v_exp_f32 v149, v85 clamp
    v_exp_f32 v153, v87 clamp
    v_max_f32 v143, s82, v81
    v_max_f32 v147, s82, v83
    v_max_f32 v151, s82, v85
    v_max_f32 v155, s82, v87
    v_pk_fma_f32 v[140:141], v[142:143], s[84:85], v[140:141]
    v_pk_fma_f32 v[144:145], v[146:147], s[84:85], v[144:145]
    v_pk_fma_f32 v[148:149], v[150:151], s[84:85], v[148:149]
    v_pk_fma_f32 v[152:153], v[154:155], s[84:85], v[152:153]
    v_cvt_pk_bf16_f32 v208, v140, v141
    v_cvt_pk_bf16_f32 v209, v144, v145
    v_cvt_pk_bf16_f32 v210, v148, v149
    v_cvt_pk_bf16_f32 v211, v152, v153
    s_nop 0
    v_permlane16_swap_b32 v208, v210
    v_permlane16_swap_b32 v209, v211
    s_add_u32 s90, s90, 4096
    buffer_store_dwordx4 v[208:211], v240, s[48:51], s90 offen offset:0 sc1
    v_lshlrev_b32 v11, 4, v0
    v_lshrrev_b32 v4, 2, v0
    v_and_b32 v5, 3, v0
    s_and_b32 s14, s3, 1
    s_mul_i32 s14, s14, 96
    v_mad_u32_u24 v5, v5, 24, s14
    v_and_b32 v6, 4, v4
    v_lshlrev_b32 v6, 3, v6
    s_lshr_b32 s14, s3, 2
    s_mul_i32 s14, s14, 55296
    s_add_u32 s14, s14, 36864
    v_mul_u32_u24 v4, 192, v4
    v_add_u32 v4, s14, v4
    v_add_u32 v7, 0, v5
    v_xor_b32 v7, v7, v6
    v_add_u32 v8, v7, v4
    v_add_u32 v7, 8, v5
    v_xor_b32 v7, v7, v6
    v_add_u32 v9, v7, v4
    v_add_u32 v7, 16, v5
    v_xor_b32 v7, v7, v6
    v_add_u32 v10, v7, v4
    s_and_b32 s16, s3, 1
    s_lshr_b32 s17, s3, 2
    s_bfe_u32 s39, s3, 0x10001
    s_lshl1_add_u32 s18, s11, s39
    s_lshl1_add_u32 s18, s18, s17
    v_mov_b32 v60, 0
    v_mov_b32 v61, 0
    v_mov_b32 v62, 0
    v_mov_b32 v63, 0
    v_mov_b32 v64, 0
    v_mov_b32 v65, 0
    v_mov_b32 v66, 0
    v_mov_b32 v67, 0
    v_mov_b32 v68, 0
    v_mov_b32 v69, 0
    v_mov_b32 v70, 0
    v_mov_b32 v71, 0
    v_mov_b32 v72, 0
    v_mov_b32 v73, 0
    v_mov_b32 v74, 0
    v_mov_b32 v75, 0
    v_mov_b32 v76, 0
    v_mov_b32 v77, 0
    v_mov_b32 v78, 0
    v_mov_b32 v79, 0
    v_mov_b32 v80, 0
    v_mov_b32 v81, 0
    v_mov_b32 v82, 0
    v_mov_b32 v83, 0
    v_mov_b32 v84, 0
    v_mov_b32 v85, 0
    v_mov_b32 v86, 0
    v_mov_b32 v87, 0
    v_mov_b32 v88, 0
    v_mov_b32 v89, 0
    v_mov_b32 v90, 0
    v_mov_b32 v91, 0
    v_and_b32 v4, 31, v0
    v_lshrrev_b32 v5, 3, v4
    v_and_b32 v6, 3, v0
    v_lshl_add_u32 v5, v5, 2, v6
    v_bfe_u32 v6, v0, 2, 1
    v_mad_u32_u24 v6, v6, 9, v5
    v_cmp_gt_u32 vcc, 9, v5
    v_lshrrev_b32 v7, 5, v0
    s_nop 0
    v_cndmask_b32 v6, 18, v6, vcc
    v_subrev_u32 v7, s16, v7
    v_cmp_gt_u32 vcc, 16, v6
    v_mov_b32 v4, 64
    v_mov_b32 v5, 256
    v_cndmask_b32 v4, v4, v5, vcc
    v_mov_b32 v5, 512
    v_cndmask_b32 v5, v5, 0, vcc
    v_lshl_add_u32 v6, v6, 4, v5
    s_lshl_b32 s20, s3, 12
    s_add_u32 s20, s20, 110592
    v_add_u32 v6, s20, v6
    v_mad_i32_i24 v12, v7, v4, v6
    v_lshl_add_u32 v139, v4, 1, v12
    s_lshl_b32 s23, s3, 12
    s_add_u32 s23, s23, 3407872
    s_cmp_eq_u32 s16, 0
    s_mov_b32 s14, 0x33ffff
    s_cselect_b32 s24, s14, 0
    s_mov_b32 s25, s14
    s_mov_b32 s26, s14
    s_cselect_b32 s27, 0, s14
    s_mul_i32 s14, s3, 72
    v_mul_u32_u24 v13, 592, v0
    v_add_u32 v13, s14, v13
    v_and_b32 v4, 1, v3
    v_lshl_add_u32 v4, v4, 5, v2
    v_mul_u32_u24 v4, 592, v4
    v_lshrrev_b32 v5, 1, v3
    v_lshl_add_u32 v4, v5, 4, v4
    s_mul_i32 s15, s39, 37888
    s_mul_i32 s14, s17, 9760
    s_add_u32 s14, s14, s15
    v_add_u32 v14, s14, v4
    s_mul_i32 s14, s17, -9184
    s_add_u32 s14, s14, s15
    s_add_u32 s14, s14, 9472
    v_add_u32 v15, s14, v4
    s_and_b32 s14, s18, 3
    s_mul_i32 s14, s14, 3072
    s_mul_i32 s15, s16, 96
    s_add_u32 s14, s14, s15
    s_add_u32 s14, s14, 147456
    v_mul_u32_u24 v4, 192, v2
    v_mad_u32_u24 v5, v3, 24, v4
    v_add_u32 v16, s14, v5
    s_add_u32 s15, s15, 162816
    v_mad_u32_u24 v136, v3, 24, s15
    v_lshlrev_b32 v4, 4, v2
    v_and_b32 v6, 7, v0
    v_lshlrev_b32 v6, 4, v6
    v_bfe_u32 v7, v0, 3, 1
    v_mul_u32_u24 v7, 1152, v7
    v_add_u32 v17, v6, v7
    v_mul_u32_u24 v5, 768, v3
    v_add_u32 v143, v5, v4
    s_lshl_b32 s14, s18, 4
    s_sub_u32 s14, 0xfff, s14
    v_sub_u32 v18, s14, v2
    s_mul_i32 s15, s3, 3072
    s_add_u32 s15, s15, 77824
    v_add_u32 v19, s15, v11
    s_xor_b32 s14, s3, 4
    s_mul_i32 s15, s14, 3072
    s_add_u32 s15, s15, 77824
    v_add_u32 v138, s15, v11
    s_mov_b32 s94, s15
    s_getreg_b32 s95, hwreg(HW_REG_XCC_ID)
    s_and_b32 s95, s95, 7
    s_or_b32 s95, s95, 8
    s_mul_i32 s28, s18, 3072
    s_add_u32 s28, s28, 3538944
    s_lshl1_add_u32 s31, s12, s16
    s_lshl_b32 s29, s31, 8
    s_add_u32 s29, s29, s28
    s_mul_i32 s30, s31, 96
    s_mul_i32 s15, s18, 2304
    s_add_u32 s30, s30, s15
    s_add_u32 s30, s30, 3932160
    s_and_b32 s14, s18, 3
    s_lshl_b32 s14, s14, 1
    s_xor_b32 s79, s31, s14
    s_lshr_b32 s14, s3, 1
    s_lshl3_add_u32 s14, s11, s14
    s_lshl_b32 s14, s14, 7
    v_lshl_add_u32 v4, v0, 9, s14
    s_lshl3_add_u32 s14, s4, s3
    s_lshl_b32 s14, s14, 7
    s_add_u32 s14, s14, 49144
    v_lshl_add_u32 v5, v0, 2, s14
    v_cmp_gt_u32 vcc, 2, v0
    s_mov_b32 s19, 3440640
    s_nop 0
    v_cndmask_b32 v140, v5, v4, vcc
    s_mul_i32 s21, s11, 73728
    s_mul_i32 s14, s3, 9
    s_lshr_b32 s14, s14, 1
    s_lshl_b32 s14, s14, 10
    s_add_u32 s21, s21, s14
    s_add_u32 s21, s21, 0
    v_mov_b32 v4, 0
    s_add_u32 s89, s89, 4096
    s_waitcnt vmcnt(0)
    s_mov_b64 exec, 1
    buffer_store_dword v253, v4, s[48:51], s91 offen
    s_mov_b32 exec_lo, -1
    s_mov_b32 exec_hi, 0xff
    buffer_load_dword v137, v241, s[48:51], s89 offen sc1
    s_mov_b64 exec, -1
    s_branch L_B_c2
    .fill 622, 4, 0xbf810000
L_B_c:
    v_lshlrev_b32 v11, 4, v0
    v_lshrrev_b32 v4, 2, v0
    v_and_b32 v5, 3, v0
    s_and_b32 s14, s3, 1
    s_mul_i32 s14, s14, 96
    v_mad_u32_u24 v5, v5, 24, s14
    v_and_b32 v6, 4, v4
    v_lshlrev_b32 v6, 3, v6
    s_lshr_b32 s14, s3, 2
    s_mul_i32 s14, s14, 55296
    s_add_u32 s14, s14, 36864
    v_mul_u32_u24 v4, 192, v4
    v_add_u32 v4, s14, v4
    v_add_u32 v7, 0, v5
    v_xor_b32 v7, v7, v6
    v_add_u32 v8, v7, v4
    v_add_u32 v7, 8, v5
    v_xor_b32 v7, v7, v6
    v_add_u32 v9, v7, v4
    v_add_u32 v7, 16, v5
    v_xor_b32 v7, v7, v6
    v_add_u32 v10, v7, v4
    s_and_b32 s16, s3, 1
    s_lshr_b32 s17, s3, 2
    s_bfe_u32 s39, s3, 0x10001
    s_lshl1_add_u32 s18, s11, s39
    s_lshl1_add_u32 s18, s18, s17
    v_mov_b32 v60, 0
    v_mov_b32 v61, 0
    v_mov_b32 v62, 0
    v_mov_b32 v63, 0
    v_mov_b32 v64, 0
    v_mov_b32 v65, 0
    v_mov_b32 v66, 0
    v_mov_b32 v67, 0
    v_mov_b32 v68, 0
    v_mov_b32 v69, 0
    v_mov_b32 v70, 0
    v_mov_b32 v71, 0
    v_mov_b32 v72, 0
    v_mov_b32 v73, 0
    v_mov_b32 v74, 0
    v_mov_b32 v75, 0
    v_mov_b32 v76, 0
    v_mov_b32 v77, 0
    v_mov_b32 v78, 0
    v_mov_b32 v79, 0
    v_mov_b32 v80, 0
    v_mov_b32 v81, 0
    v_mov_b32 v82, 0
    v_mov_b32 v83, 0
    v_mov_b32 v84, 0
    v_mov_b32 v85, 0
    v_mov_b32 v86, 0
    v_mov_b32 v87, 0
    v_mov_b32 v88, 0
    v_mov_b32 v89, 0
    v_mov_b32 v90, 0
    v_mov_b32 v91, 0
    v_and_b32 v4, 31, v0
    v_lshrrev_b32 v5, 3, v4
    v_and_b32 v6, 3, v0
    v_lshl_add_u32 v5, v5, 2, v6
    v_bfe_u32 v6, v0, 2, 1
    v_mad_u32_u24 v6, v6, 9, v5
    v_cmp_gt_u32 vcc, 9, v5
    v_lshrrev_b32 v7, 5, v0
    s_nop 0
    v_cndmask_b32 v6, 18, v6, vcc
    v_subrev_u32 v7, s16, v7
    v_cmp_gt_u32 vcc, 16, v6
    v_mov_b32 v4, 64
    v_mov_b32 v5, 256
    v_cndmask_b32 v4, v4, v5, vcc
    v_mov_b32 v5, 512
    v_cndmask_b32 v5, v5, 0, vcc
    v_lshl_add_u32 v6, v6, 4, v5
    s_lshl_b32 s20, s3, 12
    s_add_u32 s20, s20, 110592
    v_add_u32 v6, s20, v6
    v_mad_i32_i24 v12, v7, v4, v6
    v_lshl_add_u32 v139, v4, 1, v12
    s_lshl_b32 s23, s3, 12
    s_add_u32 s23, s23, 3407872
    s_cmp_eq_u32 s16, 0
    s_mov_b32 s14, 0x33ffff
    s_cselect_b32 s24, s14, 0
    s_mov_b32 s25, s14
    s_mov_b32 s26, s14
    s_cselect_b32 s27, 0, s14
    s_mul_i32 s14, s3, 72
    v_mul_u32_u24 v13, 592, v0
    v_add_u32 v13, s14, v13
    v_and_b32 v4, 1, v3
    v_lshl_add_u32 v4, v4, 5, v2
    v_mul_u32_u24 v4, 592, v4
    v_lshrrev_b32 v5, 1, v3
    v_lshl_add_u32 v4, v5, 4, v4
    s_mul_i32 s15, s39, 37888
    s_mul_i32 s14, s17, 9760
    s_add_u32 s14, s14, s15
    v_add_u32 v14, s14, v4
    s_mul_i32 s14, s17, -9184
    s_add_u32 s14, s14, s15
    s_add_u32 s14, s14, 9472
    v_add_u32 v15, s14, v4
    s_and_b32 s14, s18, 3
    s_mul_i32 s14, s14, 3072
    s_mul_i32 s15, s16, 96
    s_add_u32 s14, s14, s15
    s_add_u32 s14, s14, 147456
    v_mul_u32_u24 v4, 192, v2
    v_mad_u32_u24 v5, v3, 24, v4
    v_add_u32 v16, s14, v5
    s_add_u32 s15, s15, 162816
    v_mad_u32_u24 v136, v3, 24, s15
    v_lshlrev_b32 v4, 4, v2
    v_and_b32 v6, 7, v0
    v_lshlrev_b32 v6, 4, v6
    v_bfe_u32 v7, v0, 3, 1
    v_mul_u32_u24 v7, 1152, v7
    v_add_u32 v17, v6, v7
    v_mul_u32_u24 v5, 768, v3
    v_add_u32 v143, v5, v4
    s_lshl_b32 s14, s18, 4
    s_sub_u32 s14, 0xfff, s14
    v_sub_u32 v18, s14, v2
    s_mul_i32 s15, s3, 3072
    s_add_u32 s15, s15, 77824
    v_add_u32 v19, s15, v11
    s_xor_b32 s14, s3, 4
    s_mul_i32 s15, s14, 3072
    s_add_u32 s15, s15, 77824
    v_add_u32 v138, s15, v11
    s_mov_b32 s94, s15
    s_getreg_b32 s95, hwreg(HW_REG_XCC_ID)
    s_and_b32 s95, s95, 7
    s_or_b32 s95, s95, 8
    s_mul_i32 s28, s18, 3072
    s_add_u32 s28, s28, 3538944
    s_lshl1_add_u32 s31, s12, s16
    s_lshl_b32 s29, s31, 8
    s_add_u32 s29, s29, s28
    s_mul_i32 s30, s31, 96
    s_mul_i32 s15, s18, 2304
    s_add_u32 s30, s30, s15
    s_add_u32 s30, s30, 3932160
    s_and_b32 s14, s18, 3
    s_lshl_b32 s14, s14, 1
    s_xor_b32 s79, s31, s14
    s_lshr_b32 s14, s3, 1
    s_lshl3_add_u32 s14, s11, s14
    s_lshl_b32 s14, s14, 7
    v_lshl_add_u32 v4, v0, 9, s14
    s_lshl3_add_u32 s14, s4, s3
    s_lshl_b32 s14, s14, 7
    s_add_u32 s14, s14, 49144
    v_lshl_add_u32 v5, v0, 2, s14
    v_cmp_gt_u32 vcc, 2, v0
    s_mov_b32 s19, 3440640
    s_nop 0
    v_cndmask_b32 v140, v5, v4, vcc
    s_mul_i32 s21, s11, 73728
    s_mul_i32 s14, s3, 9
    s_lshr_b32 s14, s14, 1
    s_lshl_b32 s14, s14, 10
    s_add_u32 s21, s21, s14
    s_add_u32 s21, s21, 0
L_B_c2:
    s_mov_b32 s38, 1600000
L_cw_11:
    ds_read_b32 v1, v252 offset:16
    s_waitcnt lgkmcnt(0)
    v_readfirstlane_b32 s14, v1
    s_nop 0
    s_cmp_ge_u32 s14, 4
    s_cbranch_scc1 L_cok_12
    s_sub_u32 s38, s38, 1
    s_cbranch_scc0 L_cw_11
L_cok_12:
    ds_read_b64_tr_b16 v[144:145], v8 offset:0
    ds_read_b64_tr_b16 v[146:147], v8 offset:3072
    ds_read_b64_tr_b16 v[148:149], v9 offset:0
    ds_read_b64_tr_b16 v[150:151], v9 offset:3072
    ds_read_b64_tr_b16 v[152:153], v10 offset:0
    ds_read_b64_tr_b16 v[154:155], v10 offset:3072
    s_waitcnt lgkmcnt(8)
    ds_read_b64_tr_b16 v[156:157], v8 offset:6144
    ds_read_b64_tr_b16 v[158:159], v8 offset:9216
    ds_read_b64_tr_b16 v[160:161], v9 offset:6144
    ds_read_b64_tr_b16 v[162:163], v9 offset:9216
    ds_read_b64_tr_b16 v[164:165], v10 offset:6144
    ds_read_b64_tr_b16 v[166:167], v10 offset:9216
    s_waitcnt lgkmcnt(8)
    ds_read_b64_tr_b16 v[168:169], v8 offset:12288
    ds_read_b64_tr_b16 v[170:171], v8 offset:15360
    ds_read_b64_tr_b16 v[172:173], v9 offset:12288
    ds_read_b64_tr_b16 v[174:175], v9 offset:15360
    ds_read_b64_tr_b16 v[176:177], v10 offset:12288
    ds_read_b64_tr_b16 v[178:179], v10 offset:15360
    s_waitcnt lgkmcnt(8)
    ds_read_b64_tr_b16 v[180:181], v8 offset:18432
    ds_read_b64_tr_b16 v[182:183], v8 offset:21504
    ds_read_b64_tr_b16 v[184:185], v9 offset:18432
    ds_read_b64_tr_b16 v[186:187], v9 offset:21504
    ds_read_b64_tr_b16 v[188:189], v10 offset:18432
    ds_read_b64_tr_b16 v[190:191], v10 offset:21504
    s_waitcnt lgkmcnt(8)
    ds_read_b64_tr_b16 v[192:193], v8 offset:24576
    ds_read_b64_tr_b16 v[194:195], v8 offset:27648
    ds_read_b64_tr_b16 v[196:197], v9 offset:24576
    ds_read_b64_tr_b16 v[198:199], v9 offset:27648
    ds_read_b64_tr_b16 v[200:201], v10 offset:24576
    ds_read_b64_tr_b16 v[202:203], v10 offset:27648
    s_waitcnt lgkmcnt(8)
    ds_read_b64_tr_b16 v[204:205], v8 offset:30720
    ds_read_b64_tr_b16 v[206:207], v8 offset:33792
    ds_read_b64_tr_b16 v[208:209], v9 offset:30720
    ds_read_b64_tr_b16 v[210:211], v9 offset:33792
    ds_read_b64_tr_b16 v[212:213], v10 offset:30720
    ds_read_b64_tr_b16 v[214:215], v10 offset:33792
    s_waitcnt lgkmcnt(8)
    ds_read_b64_tr_b16 v[216:217], v8 offset:36864
    ds_read_b64_tr_b16 v[218:219], v8 offset:39936
    ds_read_b64_tr_b16 v[220:221], v9 offset:36864
    ds_read_b64_tr_b16 v[222:223], v9 offset:39936
    ds_read_b64_tr_b16 v[224:225], v10 offset:36864
    ds_read_b64_tr_b16 v[226:227], v10 offset:39936
    s_waitcnt lgkmcnt(8)
    ds_read_b64_tr_b16 v[228:229], v8 offset:43008
    ds_read_b64_tr_b16 v[230:231], v8 offset:46080
    ds_read_b64_tr_b16 v[232:233], v9 offset:43008
    ds_read_b64_tr_b16 v[234:235], v9 offset:46080
    ds_read_b64_tr_b16 v[236:237], v10 offset:43008
    ds_read_b64_tr_b16 v[238:239], v10 offset:46080
    s_waitcnt lgkmcnt(8)
    ds_read_b64_tr_b16 v[240:241], v8 offset:49152
    ds_read_b64_tr_b16 v[242:243], v8 offset:52224
    ds_read_b64_tr_b16 v[244:245], v9 offset:49152
    ds_read_b64_tr_b16 v[246:247], v9 offset:52224
    ds_read_b64_tr_b16 v[248:249], v10 offset:49152
    ds_read_b64_tr_b16 v[250:251], v10 offset:52224
    s_waitcnt lgkmcnt(8)
    s_waitcnt lgkmcnt(0)
    s_mov_b64 exec, 1
    ds_add_u32 v252, v253 offset:32
    s_mov_b64 exec, -1
L_phaseB:
    s_mov_b32 s38, 400000
    s_mov_b64 exec, 63
L_pqpoll:
    buffer_load_dword v142, v140, s[48:51], s19 offen sc1
    s_waitcnt vmcnt(0)
L_pqchk:
    v_cmp_eq_u32 vcc, 0, v142
    s_nop 0
    s_and_b32 s22, vcc_lo, 3
    s_cbranch_scc0 L_pqok
    s_cmp_lg_u32 s38, 399992
    s_cbranch_scc1 L_pqnof
    s_cmp_eq_u32 s93, 0
    s_cbranch_scc1 L_gf_13
    v_mov_b32 v4, 0
    buffer_store_dword v253, v4, s[48:51], s93 offen sc1
L_gf_13:
L_pqnof:
    s_sleep 2
    s_sub_u32 s38, s38, 1
    s_cbranch_scc0 L_pqpoll
L_pqok:
    s_or_b32 s22, vcc_lo, vcc_hi
    s_mov_b64 exec, -1
    s_cmp_ge_u32 s7, 4
    s_cbranch_scc1 L_B_nogate
    s_mov_b32 s38, 1600000
L_cw_14:
    ds_read_b32 v1, v252 offset:8
    s_waitcnt lgkmcnt(0)
    v_readfirstlane_b32 s14, v1
    s_nop 0
    s_cmp_ge_u32 s14, 2
    s_cbranch_scc1 L_cok_15
    s_sleep 1
    s_sub_u32 s38, s38, 1
    s_cbranch_scc0 L_cw_14
L_cok_15:
L_B_nogate:
    buffer_load_dwordx4 v[20:23], v11, s[48:51], s21 offen offset:0 sc1
    buffer_load_dwordx4 v[24:27], v11, s[48:51], s21 offen offset:1024 sc1
    buffer_load_dwordx4 v[28:31], v11, s[48:51], s21 offen offset:2048 sc1
    buffer_load_dwordx4 v[32:35], v11, s[48:51], s21 offen offset:3072 sc1
    s_add_u32 s21, s21, 4096
    buffer_load_dwordx4 v[36:39], v11, s[48:51], s21 offen offset:0 sc1
    s_add_u32 s21, s21, 32768
    s_cmp_eq_u32 s93, 0
    s_cbranch_scc1 L_gf_16
    v_mov_b32 v4, 0
    buffer_store_dword v253, v4, s[48:51], s93 offen sc1
L_gf_16:
    s_mov_b32 s38, 1600000
L_cw_17:
    ds_read_b32 v1, v252 offset:32
    s_waitcnt lgkmcnt(0)
    v_readfirstlane_b32 s14, v1
    s_nop 0
    s_cmp_ge_u32 s14, 8
    s_cbranch_scc1 L_cok_18
    s_sub_u32 s38, s38, 1
    s_cbranch_scc0 L_cw_17
L_cok_18:
    ds_read_b64 v[92:93], v136 offset:0
    ds_read_b64 v[94:95], v136 offset:8
    ds_read_b64 v[96:97], v136 offset:16
    v_mov_b32 v141, 0
    v_mov_b32 v4, 0x3f803f80
    s_waitcnt lgkmcnt(0)
    v_dot2c_f32_bf16 v141, v92, v4
    v_dot2c_f32_bf16 v141, v93, v4
    v_dot2c_f32_bf16 v141, v94, v4
    v_dot2c_f32_bf16 v141, v95, v4
    v_dot2c_f32_bf16 v141, v96, v4
    v_dot2c_f32_bf16 v141, v97, v4
    s_cmp_eq_u32 s22, 0
    s_cbranch_scc1 L_B_hintok
    s_mov_b32 s38, 24
    s_mov_b64 exec, 60
L_B_hint:
    buffer_load_dword v142, v140, s[48:51], s19 offen sc1
    s_waitcnt vmcnt(0)
    v_cmp_eq_u32 vcc, 0, v142
    s_cbranch_vccz L_B_hintok
    s_sleep 0
    s_sub_u32 s38, s38, 1
    s_cbranch_scc0 L_B_hint
L_B_hintok:
    s_mov_b64 exec, -1
    s_mov_b32 s38, 400000
    s_mov_b32 m0, s20
    s_nop 0
    buffer_load_dwordx4 v11, s[48:51], s23 offen offset:0 sc1 lds
    buffer_load_dwordx4 v11, s[48:51], s23 offen offset:1024 sc1 lds
    buffer_load_dwordx4 v11, s[48:51], s23 offen offset:2048 sc1 lds
    buffer_load_dwordx4 v11, s[48:51], s23 offen offset:3072 sc1 lds
    s_setprio 2
    s_cmp_ge_u32 s3, 4
    s_cbranch_scc1 L_B_nolp
    s_setprio 3
L_B_nolp:
    s_waitcnt vmcnt(0)
L_B_kvchk:
    s_mov_b64 exec, s[24:25]
    ds_read_b128 v[60:63], v12 offset:0
    ds_read_b128 v[68:71], v12 offset:1024
    ds_read_b128 v[76:79], v12 offset:2048
    ds_read_b128 v[84:87], v12 offset:3072
    s_mov_b64 exec, s[26:27]
    ds_read_b128 v[64:67], v139 offset:0
    ds_read_b128 v[72:75], v139 offset:1024
    ds_read_b128 v[80:83], v139 offset:2048
    ds_read_b128 v[88:91], v139 offset:3072
    s_mov_b64 exec, -1
    s_waitcnt lgkmcnt(4)
    v_mfma_f32_32x32x16_bf16 v[92:107], v[60:63], v[20:23], 0
    v_min3_u32 v4, v60, v61, v62
    v_min3_u32 v5, v63, v68, v69
    v_min3_u32 v4, v4, v70, v71
    v_min3_u32 v5, v5, v76, v77
    v_min3_u32 v4, v4, v78, v79
    s_waitcnt lgkmcnt(0)
    v_mfma_f32_32x32x16_bf16 v[92:107], v[64:67], v[24:27], v[92:107]
    v_min3_u32 v5, v5, v84, v85
    v_min3_u32 v4, v4, v86, v87
    v_min_u32 v4, v4, v5
    v_cmp_eq_u32 s[14:15], 0, v4
    v_mfma_f32_32x32x16_bf16 v[108:123], v[68:71], v[24:27], 0
    v_min3_u32 v4, v64, v65, v66
    v_min3_u32 v5, v67, v72, v73
    v_min3_u32 v4, v4, v74, v75
    v_min3_u32 v5, v5, v80, v81
    v_min3_u32 v4, v4, v82, v83
    v_mfma_f32_32x32x16_bf16 v[108:123], v[72:75], v[28:31], v[108:123]
    v_min3_u32 v5, v5, v88, v89
    v_min3_u32 v4, v4, v90, v91
    v_min_u32 v4, v4, v5
    v_cmp_eq_u32 vcc, 0, v4
    s_and_b64 s[14:15], s[14:15], s[24:25]
    s_and_b64 vcc, vcc, s[26:27]
    s_or_b64 s[14:15], s[14:15], vcc
    s_cbranch_scc1 L_B_kvretry
L_B_kvok:
    buffer_load_dwordx4 v[40:43], v11, s[48:51], s21 offen offset:0 sc1
    buffer_load_dwordx4 v[44:47], v11, s[48:51], s21 offen offset:1024 sc1
    buffer_load_dwordx4 v[48:51], v11, s[48:51], s21 offen offset:2048 sc1
    buffer_load_dwordx4 v[52:55], v11, s[48:51], s21 offen offset:3072 sc1
    s_add_u32 s21, s21, 4096
    buffer_load_dwordx4 v[56:59], v11, s[48:51], s21 offen offset:0 sc1
    v_add_f32 v102, 0x358637bd, v101
    v_rcp_f32 v102, v102
    s_nop 0
    v_mul_f32 v92, v92, v102
    v_mul_f32 v93, v93, v102
    v_mul_f32 v94, v94, v102
    v_mul_f32 v95, v95, v102
    v_mul_f32 v96, v96, v102
    v_mul_f32 v97, v97, v102
    v_mul_f32 v98, v98, v102
    v_mul_f32 v99, v99, v102
    v_mul_f32 v4, v100, v102
    v_cvt_pk_bf16_f32 v124, v92, v93
    v_cvt_pk_bf16_f32 v125, v94, v95
    v_cvt_pk_bf16_f32 v126, v96, v97
    v_cvt_pk_bf16_f32 v127, v98, v99
    v_mfma_f32_32x32x16_bf16 v[92:107], v[76:79], v[28:31], 0
    ds_write_b64 v13, v[124:125] offset:0
    ds_write_b64 v13, v[126:127] offset:8
    v_add_f32 v118, 0x358637bd, v117
    v_rcp_f32 v118, v118
    v_mfma_f32_32x32x16_bf16 v[92:107], v[80:83], v[32:35], v[92:107]
    v_mul_f32 v108, v108, v118
    v_mul_f32 v109, v109, v118
    v_mul_f32 v110, v110, v118
    v_mul_f32 v111, v111, v118
    v_mul_f32 v112, v112, v118
    v_mul_f32 v113, v113, v118
    v_mul_f32 v114, v114, v118
    v_mul_f32 v115, v115, v118
    v_mul_f32 v116, v116, v118
    v_cvt_pk_bf16_f32 v128, v4, v108
    v_cvt_pk_bf16_f32 v129, v109, v110
    v_cvt_pk_bf16_f32 v130, v111, v112
    v_cvt_pk_bf16_f32 v131, v113, v114
    v_cvt_pk_bf16_f32 v132, v115, v116
    v_mfma_f32_32x32x16_bf16 v[108:123], v[84:87], v[32:35], 0
    ds_write_b64 v13, v[128:129] offset:16
    ds_write_b64 v13, v[130:131] offset:24
    v_add_f32 v102, 0x358637bd, v101
    v_rcp_f32 v102, v102
    v_mfma_f32_32x32x16_bf16 v[108:123], v[88:91], v[36:39], v[108:123]
    v_mul_f32 v92, v92, v102
    v_mul_f32 v93, v93, v102
    v_mul_f32 v94, v94, v102
    v_mul_f32 v95, v95, v102
    v_mul_f32 v96, v96, v102
    v_mul_f32 v97, v97, v102
    v_mul_f32 v98, v98, v102
    v_mul_f32 v99, v99, v102
    v_mul_f32 v4, v100, v102
    v_cvt_pk_bf16_f32 v133, v92, v93
    v_cvt_pk_bf16_f32 v134, v94, v95
    v_cvt_pk_bf16_f32 v135, v96, v97
    v_cvt_pk_bf16_f32 v124, v98, v99
    s_waitcnt vmcnt(0)
    v_mfma_f32_32x32x16_bf16 v[92:107], v[60:63], v[40:43], 0
    ds_write_b64 v13, v[132:133] offset:32
    ds_write_b64 v13, v[134:135] offset:40
    v_add_f32 v118, 0x358637bd, v117
    v_rcp_f32 v118, v118
    v_mfma_f32_32x32x16_bf16 v[92:107], v[64:67], v[44:47], v[92:107]
    v_mul_f32 v108, v108, v118
    v_mul_f32 v109, v109, v118
    v_mul_f32 v110, v110, v118
    v_mul_f32 v111, v111, v118
    v_mul_f32 v112, v112, v118
    v_mul_f32 v113, v113, v118
    v_mul_f32 v114, v114, v118
    v_mul_f32 v115, v115, v118
    v_mul_f32 v116, v116, v118
    v_cvt_pk_bf16_f32 v125, v4, v108
    v_cvt_pk_bf16_f32 v126, v109, v110
    v_cvt_pk_bf16_f32 v127, v111, v112
    v_cvt_pk_bf16_f32 v128, v113, v114
    v_cvt_pk_bf16_f32 v129, v115, v116
    v_mfma_f32_32x32x16_bf16 v[108:123], v[68:71], v[44:47], 0
    ds_write_b64 v13, v[124:125] offset:48
    ds_write_b64 v13, v[126:127] offset:56
    ds_write_b64 v13, v[128:129] offset:64
    v_add_f32 v102, 0x358637bd, v101
    v_rcp_f32 v102, v102
    v_mfma_f32_32x32x16_bf16 v[108:123], v[72:75], v[48:51], v[108:123]
    v_mul_f32 v92, v92, v102
    v_mul_f32 v93, v93, v102
    v_mul_f32 v94, v94, v102
    v_mul_f32 v95, v95, v102
    v_mul_f32 v96, v96, v102
    v_mul_f32 v97, v97, v102
    v_mul_f32 v98, v98, v102
    v_mul_f32 v99, v99, v102
    v_mul_f32 v4, v100, v102
    v_cvt_pk_bf16_f32 v130, v92, v93
    v_cvt_pk_bf16_f32 v131, v94, v95
    v_cvt_pk_bf16_f32 v132, v96, v97
    v_cvt_pk_bf16_f32 v133, v98, v99
    v_mfma_f32_32x32x16_bf16 v[92:107], v[76:79], v[48:51], 0
    ds_write_b64 v13, v[130:131] offset:37888
    ds_write_b64 v13, v[132:133] offset:37896
    v_add_f32 v118, 0x358637bd, v117
    v_rcp_f32 v118, v118
    v_mfma_f32_32x32x16_bf16 v[92:107], v[80:83], v[52:55], v[92:107]
    v_mul_f32 v108, v108, v118
    v_mul_f32 v109, v109, v118
    v_mul_f32 v110, v110, v118
    v_mul_f32 v111, v111, v118
    v_mul_f32 v112, v112, v118
    v_mul_f32 v113, v113, v118
    v_mul_f32 v114, v114, v118
    v_mul_f32 v115, v115, v118
    v_mul_f32 v116, v116, v118
    v_cvt_pk_bf16_f32 v134, v4, v108
    v_cvt_pk_bf16_f32 v135, v109, v110
    v_cvt_pk_bf16_f32 v124, v111, v112
    v_cvt_pk_bf16_f32 v125, v113, v114
    v_cvt_pk_bf16_f32 v126, v115, v116
    v_mfma_f32_32x32x16_bf16 v[108:123], v[84:87], v[52:55], 0
    ds_write_b64 v13, v[134:135] offset:37904
    ds_write_b64 v13, v[124:125] offset:37912
    v_add_f32 v102, 0x358637bd, v101
    v_rcp_f32 v102, v102
    v_mfma_f32_32x32x16_bf16 v[108:123], v[88:91], v[56:59], v[108:123]
    v_mul_f32 v92, v92, v102
    v_mul_f32 v93, v93, v102
    v_mul_f32 v94, v94, v102
    v_mul_f32 v95, v95, v102
    v_mul_f32 v96, v96, v102
    v_mul_f32 v97, v97, v102
    v_mul_f32 v98, v98, v102
    v_mul_f32 v99, v99, v102
    v_mul_f32 v4, v100, v102
    v_cvt_pk_bf16_f32 v127, v92, v93
    v_cvt_pk_bf16_f32 v128, v94, v95
    v_cvt_pk_bf16_f32 v129, v96, v97
    v_cvt_pk_bf16_f32 v130, v98, v99
    ds_write_b64 v13, v[126:127] offset:37920
    ds_write_b64 v13, v[128:129] offset:37928
    v_add_f32 v118, 0x358637bd, v117
    v_rcp_f32 v118, v118
    s_nop 0
    v_mul_f32 v108, v108, v118
    v_mul_f32 v109, v109, v118
    v_mul_f32 v110, v110, v118
    v_mul_f32 v111, v111, v118
    v_mul_f32 v112, v112, v118
    v_mul_f32 v113, v113, v118
    v_mul_f32 v114, v114, v118
    v_mul_f32 v115, v115, v118
    v_mul_f32 v116, v116, v118
    v_cvt_pk_bf16_f32 v131, v4, v108
    v_cvt_pk_bf16_f32 v132, v109, v110
    v_cvt_pk_bf16_f32 v133, v111, v112
    v_cvt_pk_bf16_f32 v134, v113, v114
    v_cvt_pk_bf16_f32 v135, v115, v116
    ds_write_b64 v13, v[130:131] offset:37936
    ds_write_b64 v13, v[132:133] offset:37944
    ds_write_b64 v13, v[134:135] offset:37952
    s_lshl_b32 s14, s17, 2
    v_add_u32 v252, s14, v252
    s_mov_b64 exec, 1
    ds_add_u32 v252, v253 offset:40
    s_mov_b64 exec, -1
    s_mov_b32 s38, 1600000
L_cw_19:
    ds_read_b32 v1, v252 offset:40
    s_waitcnt lgkmcnt(0)
    v_readfirstlane_b32 s14, v1
    s_nop 0
    s_cmp_ge_u32 s14, 4
    s_cbranch_scc1 L_cok_20
    s_sleep 1
    s_sub_u32 s38, s38, 1
    s_cbranch_scc0 L_cw_19
L_cok_20:
    ds_read_b128 v[44:47], v15 offset:0
    ds_read_b128 v[48:51], v15 offset:32
    ds_read_b128 v[52:55], v15 offset:64
    ds_read_b128 v[56:59], v15 offset:96
    s_waitcnt lgkmcnt(3)
    v_mfma_f32_16x16x32_bf16 v[32:35], v[144:147], v[44:47], 0
    v_mov_b32 v96, 0
    v_mfma_f32_16x16x32_bf16 v[36:39], v[148:151], v[44:47], 0
    v_mov_b32 v97, 0
    v_mfma_f32_16x16x32_bf16 v[40:43], v[152:155], v[44:47], 0
    v_mov_b32 v98, 0
    ds_read_b128 v[60:63], v15 offset:128
    ds_read_b128 v[64:67], v15 offset:160
    ds_read_b64 v[108:109], v16 offset:0
    ds_read_b64 v[110:111], v16 offset:8
    s_waitcnt lgkmcnt(6)
    v_mfma_f32_16x16x32_bf16 v[32:35], v[156:159], v[48:51], v[32:35]
    v_mov_b32 v100, 0x3f803f80
    v_mfma_f32_16x16x32_bf16 v[36:39], v[160:163], v[48:51], v[36:39]
    v_mfma_f32_16x16x32_bf16 v[40:43], v[164:167], v[48:51], v[40:43]
    ds_read_b64 v[112:113], v16 offset:16
    ds_read_b64 v[122:123], v136 offset:0
    ds_read_b64 v[124:125], v136 offset:8
    ds_read_b64 v[126:127], v136 offset:16
    s_waitcnt lgkmcnt(9)
    v_mfma_f32_16x16x32_bf16 v[32:35], v[168:171], v[52:55], v[32:35]
    v_mfma_f32_16x16x32_bf16 v[36:39], v[172:175], v[52:55], v[36:39]
    v_mfma_f32_16x16x32_bf16 v[40:43], v[176:179], v[52:55], v[40:43]
    ds_read_b128 v[68:71], v15 offset:192
    ds_read_b128 v[72:75], v15 offset:224
    ds_read_b128 v[76:79], v15 offset:256
    ds_read_b128 v[80:83], v14 offset:0
    s_waitcnt lgkmcnt(12)
    v_mfma_f32_16x16x32_bf16 v[32:35], v[180:183], v[56:59], v[32:35]
    v_mfma_f32_16x16x32_bf16 v[36:39], v[184:187], v[56:59], v[36:39]
    v_mfma_f32_16x16x32_bf16 v[40:43], v[188:191], v[56:59], v[40:43]
    ds_read_b128 v[44:47], v14 offset:32
    ds_read_b128 v[48:51], v14 offset:64
    v_lshlrev_b32 v4, 7, v0
    s_mov_b64 exec, 3
    buffer_load_dword v142, v4, s[48:51], s29 offen sc1
    s_mov_b64 exec, -1
    s_waitcnt lgkmcnt(5)
    v_mfma_f32_16x16x32_bf16 v[32:35], v[192:195], v[60:63], v[32:35]
    v_lshlrev_b32 v20, 16, v108
    v_mfma_f32_16x16x32_bf16 v[36:39], v[196:199], v[60:63], v[36:39]
    v_and_b32 v21, 0xffff0000, v108
    v_mfma_f32_16x16x32_bf16 v[40:43], v[200:203], v[60:63], v[40:43]
    v_lshlrev_b32 v22, 16, v109
    ds_read_b128 v[52:55], v14 offset:96
    v_mfma_f32_16x16x32_bf16 v[32:35], v[204:207], v[64:67], v[32:35]
    v_and_b32 v23, 0xffff0000, v109
    v_mfma_f32_16x16x32_bf16 v[36:39], v[208:211], v[64:67], v[36:39]
    v_lshlrev_b32 v24, 16, v110
    v_mfma_f32_16x16x32_bf16 v[40:43], v[212:215], v[64:67], v[40:43]
    v_and_b32 v25, 0xffff0000, v110
    ds_read_b128 v[56:59], v14 offset:128
    v_mfma_f32_16x16x32_bf16 v[32:35], v[216:219], v[68:71], v[32:35]
    v_lshlrev_b32 v26, 16, v111
    v_mfma_f32_16x16x32_bf16 v[36:39], v[220:223], v[68:71], v[36:39]
    v_and_b32 v27, 0xffff0000, v111
    v_mfma_f32_16x16x32_bf16 v[40:43], v[224:227], v[68:71], v[40:43]
    v_lshlrev_b32 v28, 16, v112
    ds_read_b128 v[60:63], v14 offset:160
    s_waitcnt lgkmcnt(5)
    v_mfma_f32_16x16x32_bf16 v[32:35], v[228:231], v[72:75], v[32:35]
    v_and_b32 v29, 0xffff0000, v112
    v_mfma_f32_16x16x32_bf16 v[36:39], v[232:235], v[72:75], v[36:39]
    v_lshlrev_b32 v30, 16, v113
    v_mfma_f32_16x16x32_bf16 v[40:43], v[236:239], v[72:75], v[40:43]
    v_and_b32 v31, 0xffff0000, v113
    ds_read_b128 v[64:67], v14 offset:192
    v_mfma_f32_16x16x32_bf16 v[32:35], v[240:243], v[76:79], v[32:35]
    v_mfma_f32_16x16x32_bf16 v[36:39], v[244:247], v[76:79], v[36:39]
    v_mfma_f32_16x16x32_bf16 v[40:43], v[248:251], v[76:79], v[40:43]
    ds_read_b128 v[68:71], v14 offset:224
    v_mfma_f32_16x16x32_bf16 v[20:23], v[144:147], v[80:83], v[20:23]
    v_mfma_f32_16x16x32_bf16 v[24:27], v[148:151], v[80:83], v[24:27]
    v_mfma_f32_16x16x32_bf16 v[28:31], v[152:155], v[80:83], v[28:31]
    ds_read_b128 v[72:75], v14 offset:256
    s_waitcnt lgkmcnt(5)
    v_mfma_f32_16x16x32_bf16 v[20:23], v[156:159], v[44:47], v[20:23]
    v_mfma_f32_16x16x32_bf16 v[24:27], v[160:163], v[44:47], v[24:27]
    v_mfma_f32_16x16x32_bf16 v[28:31], v[164:167], v[44:47], v[28:31]
    ds_write_b128 v19, v[32:35] offset:0
    ds_write_b128 v19, v[36:39] offset:1024
    ds_write_b128 v19, v[40:43] offset:2048
    v_mfma_f32_16x16x32_bf16 v[20:23], v[168:171], v[48:51], v[20:23]
    v_mfma_f32_16x16x32_bf16 v[24:27], v[172:175], v[48:51], v[24:27]
    v_mfma_f32_16x16x32_bf16 v[28:31], v[176:179], v[48:51], v[28:31]
    v_mfma_f32_16x16x32_bf16 v[20:23], v[180:183], v[52:55], v[20:23]
    v_mfma_f32_16x16x32_bf16 v[24:27], v[184:187], v[52:55], v[24:27]
    v_mfma_f32_16x16x32_bf16 v[28:31], v[188:191], v[52:55], v[28:31]
    s_waitcnt lgkmcnt(5)
    v_mfma_f32_16x16x32_bf16 v[20:23], v[192:195], v[56:59], v[20:23]
    v_mfma_f32_16x16x32_bf16 v[24:27], v[196:199], v[56:59], v[24:27]
    v_mfma_f32_16x16x32_bf16 v[28:31], v[200:203], v[56:59], v[28:31]
    v_mfma_f32_16x16x32_bf16 v[20:23], v[204:207], v[60:63], v[20:23]
    v_mfma_f32_16x16x32_bf16 v[24:27], v[208:211], v[60:63], v[24:27]
    v_mfma_f32_16x16x32_bf16 v[28:31], v[212:215], v[60:63], v[28:31]
    s_waitcnt lgkmcnt(0)
    s_barrier
    s_setprio 2
    ds_read_b128 v[84:87], v138 offset:0
    ds_read_b128 v[88:91], v138 offset:1024
    ds_read_b128 v[92:95], v138 offset:2048
    v_mfma_f32_16x16x32_bf16 v[20:23], v[216:219], v[64:67], v[20:23]
    v_mfma_f32_16x16x32_bf16 v[24:27], v[220:223], v[64:67], v[24:27]
    v_mfma_f32_16x16x32_bf16 v[28:31], v[224:227], v[64:67], v[28:31]
    v_mfma_f32_16x16x32_bf16 v[20:23], v[228:231], v[68:71], v[20:23]
    v_mfma_f32_16x16x32_bf16 v[24:27], v[232:235], v[68:71], v[24:27]
    v_mfma_f32_16x16x32_bf16 v[28:31], v[236:239], v[68:71], v[28:31]
    v_mfma_f32_16x16x32_bf16 v[20:23], v[240:243], v[72:75], v[20:23]
    v_mfma_f32_16x16x32_bf16 v[24:27], v[244:247], v[72:75], v[24:27]
    v_mfma_f32_16x16x32_bf16 v[28:31], v[248:251], v[72:75], v[28:31]
L_B_xdone:
    s_waitcnt lgkmcnt(0)
    s_nop 4
    v_pk_add_f32 v[84:85], v[84:85], v[20:21]
    v_pk_add_f32 v[86:87], v[86:87], v[22:23]
    v_pk_add_f32 v[88:89], v[88:89], v[24:25]
    v_pk_add_f32 v[90:91], v[90:91], v[26:27]
    v_pk_add_f32 v[92:93], v[92:93], v[28:29]
    v_pk_add_f32 v[94:95], v[94:95], v[30:31]
    v_cvt_pk_bf16_f32 v56, v84, v85
    v_cvt_pk_bf16_f32 v57, v86, v87
    v_cvt_pk_bf16_f32 v58, v88, v89
    v_cvt_pk_bf16_f32 v59, v90, v91
    v_cvt_pk_bf16_f32 v60, v92, v93
    v_cvt_pk_bf16_f32 v61, v94, v95
    v_dot2c_f32_bf16 v96, v56, v100
    v_dot2c_f32_bf16 v97, v56, v56
    v_dot2c_f32_bf16 v98, v56, v122
    v_dot2c_f32_bf16 v96, v57, v100
    v_dot2c_f32_bf16 v97, v57, v57
    v_dot2c_f32_bf16 v98, v57, v123
    v_dot2c_f32_bf16 v96, v58, v100
    v_dot2c_f32_bf16 v97, v58, v58
    v_dot2c_f32_bf16 v98, v58, v124
    v_dot2c_f32_bf16 v96, v59, v100
    v_dot2c_f32_bf16 v97, v59, v59
    v_dot2c_f32_bf16 v98, v59, v125
    v_dot2c_f32_bf16 v96, v60, v100
    v_dot2c_f32_bf16 v97, v60, v60
    v_dot2c_f32_bf16 v98, v60, v126
    v_dot2c_f32_bf16 v96, v61, v100
    v_dot2c_f32_bf16 v97, v61, v61
    v_dot2c_f32_bf16 v98, v61, v127
    s_nop 1
    v_permlane16_swap_b32 v96, v97
    v_permlane16_swap_b32 v98, v141
    v_add_f32 v96, v96, v97
    v_add_f32 v98, v98, v141
    s_nop 1
    v_permlane32_swap_b32 v96, v98
    v_add_f32 v96, v96, v98
    v_max_u32 v116, 1, v96
    v_mov_b32 v117, v116
    s_nop 1
    v_permlane16_swap_b32 v116, v117
    v_mov_b32 v118, v116
    v_mov_b32 v119, v117
    s_nop 0
    v_permlane32_swap_b32 v116, v118
    v_permlane32_swap_b32 v117, v119
    v_and_or_b32 v119, v119, -16, s95
    s_mov_b64 exec, 0xffff
    buffer_store_dwordx4 v[116:119], v11, s[48:51], s29 offen
    s_mov_b64 exec, -1
    s_mov_b32 s38, 400000
    s_cmp_lg_u32 s79, 0
    s_cbranch_scc1 L_B_h1other
    s_setprio 3
    buffer_load_dwordx4 v[68:71], v143, s[48:51], s28 offen offset:0 sc1
    buffer_load_dwordx4 v[72:75], v143, s[48:51], s28 offen offset:256 sc1
    buffer_load_dwordx4 v[76:79], v143, s[48:51], s28 offen offset:512 sc1
    v_lshlrev_b32 v124, 16, v56
    v_and_b32 v125, 0xffff0000, v56
    v_lshlrev_b32 v126, 16, v57
    v_and_b32 v127, 0xffff0000, v57
    v_lshlrev_b32 v128, 16, v58
    v_and_b32 v129, 0xffff0000, v58
    v_lshlrev_b32 v130, 16, v59
    v_and_b32 v131, 0xffff0000, v59
    v_lshlrev_b32 v132, 16, v60
    v_and_b32 v133, 0xffff0000, v60
    v_lshlrev_b32 v134, 16, v61
    v_and_b32 v135, 0xffff0000, v61
    buffer_load_dwordx4 v[68:71], v143, s[48:51], s28 offen offset:0 sc1
    buffer_load_dwordx4 v[72:75], v143, s[48:51], s28 offen offset:256 sc1
    buffer_load_dwordx4 v[76:79], v143, s[48:51], s28 offen offset:512 sc1
L_B_h1pollb:
    buffer_load_dwordx4 v[68:71], v143, s[48:51], s28 offen offset:0 sc1
    buffer_load_dwordx4 v[72:75], v143, s[48:51], s28 offen offset:256 sc1
    buffer_load_dwordx4 v[76:79], v143, s[48:51], s28 offen offset:512 sc1
    s_waitcnt vmcnt(6)
    v_min3_u32 v4, v68, v69, v70
    v_min3_u32 v5, v71, v72, v73
    v_min3_u32 v4, v4, v74, v75
    v_min3_u32 v5, v5, v76, v77
    v_min3_u32 v4, v4, v78, v79
    v_min_u32 v4, v4, v5
    v_cmp_eq_u32 vcc, 0, v4
    s_cbranch_vccz L_B_h1okb
    s_cmp_lg_u32 s38, 399964
    s_cbranch_scc1 L_B_h1nostb
    s_mov_b64 exec, 0xffff
    buffer_store_dwordx4 v[116:119], v11, s[48:51], s29 offen sc1
    s_mov_b64 exec, -1
L_B_h1nostb:
    s_sub_u32 s38, s38, 1
    s_cbranch_scc0 L_B_h1pollb
L_B_h1okb:
    s_mov_b64 exec, -1
    v_and_b32 v4, -16, v71
    v_and_b32 v5, -16, v75
    v_and_b32 v6, -16, v79
    v_pk_add_f32 v[112:113], v[68:69], v[72:73]
    v_add_f32 v114, v70, v74
    v_add_f32 v115, v4, v5
    v_pk_add_f32 v[112:113], v[112:113], v[76:77]
    v_add_f32 v114, v114, v78
    v_add_f32 v115, v115, v6
    v_permlane16_swap_b32 v112, v113
    s_nop 0
    v_permlane16_swap_b32 v114, v115
    v_add_f32 v112, v112, v113
    v_add_f32 v114, v114, v115
    s_nop 1
    v_permlane32_swap_b32 v112, v114
    v_add_f32 v112, v112, v114
    v_mov_b32 v113, v112
    s_nop 1
    v_permlane16_swap_b32 v112, v113
    v_mov_b32 v114, v112
    v_mov_b32 v115, v113
    s_nop 0
    v_permlane32_swap_b32 v112, v114
    v_permlane32_swap_b32 v113, v115
    v_mul_f32 v100, 0x3ae38e39, v112
    v_mul_f32 v4, v100, v100
    s_mov_b32 s14, 0x3ae38e39
    v_fma_f32 v4, v113, s14, -v4
    v_max_f32 v4, 0, v4
    v_cvt_pk_bf16_f32 v4, v100, v4
    v_lshlrev_b32 v100, 16, v4
    v_and_b32 v4, 0xffff0000, v4
    v_add_f32 v4, 0x3727c5ac, v4
    v_cvt_pk_bf16_f32 v4, v4, v4
    v_lshlrev_b32 v4, 16, v4
    v_sqrt_f32 v4, v4
    s_nop 0
    v_cvt_pk_bf16_f32 v4, v4, v4
    v_lshlrev_b32 v4, 16, v4
    v_rcp_f32 v102, v4
    v_fma_f32 v5, -v100, v115, v114
    v_mul_f32 v5, v5, v102
    v_cvt_pk_bf16_f32 v5, v5, v5
    v_ashrrev_i32 v6, 31, v5
    v_or_b32 v6, 0x80000000, v6
    v_xor_b32 v5, v5, v6
    s_mov_b32 s14, 0xffff0000
    v_and_or_b32 v110, v5, s14, v18
    s_cmp_lg_u32 s79, 0
    s_cbranch_scc1 L_B_nokey
    s_lshl_b32 s14, s4, 10
    s_and_b32 s15, s18, 15
    s_lshl2_add_u32 s14, s15, s14
    s_add_u32 s14, s14, 3489856
    s_mov_b64 exec, 1
    buffer_store_dword v253, v11, s[48:51], s14 offen
    s_mov_b64 exec, -1
    v_max_u32_dpp v62, v110, v110 row_ror:8 row_mask:0xf bank_mask:0xf
    v_min_u32_dpp v63, v110, v110 row_ror:8 row_mask:0xf bank_mask:0xf
    s_lshl_b32 s14, s18, 3
    v_min_u32_dpp v64, v62, v62 row_ror:4 row_mask:0xf bank_mask:0xf
    v_max_u32_dpp v62, v62, v62 row_ror:4 row_mask:0xf bank_mask:0xf
    v_max_u32_dpp v65, v63, v63 row_ror:4 row_mask:0xf bank_mask:0xf
    v_max_u32 v63, v64, v65
    v_min_u32_dpp v64, v62, v62 row_ror:2 row_mask:0xf bank_mask:0xf
    v_max_u32_dpp v62, v62, v62 row_ror:2 row_mask:0xf bank_mask:0xf
    v_max_u32_dpp v65, v63, v63 row_ror:2 row_mask:0xf bank_mask:0xf
    v_max_u32 v63, v64, v65
    v_min_u32_dpp v64, v62, v62 row_ror:1 row_mask:0xf bank_mask:0xf
    v_max_u32_dpp v62, v62, v62 row_ror:1 row_mask:0xf bank_mask:0xf
    v_max_u32_dpp v65, v63, v63 row_ror:1 row_mask:0xf bank_mask:0xf
    v_max_u32 v63, v64, v65
    s_add_u32 s14, s14, 3473408
    s_mov_b64 exec, 1
    buffer_store_dwordx2 v[62:63], v11, s[48:51], s14 offen sc1
    s_mov_b64 exec, -1
    s_setprio 1
L_B_nokey:
    v_pk_add_f32 v[44:45], v[124:125], v[100:101] op_sel:[0,0] op_sel_hi:[1,0] neg_lo:[0,1] neg_hi:[0,1]
    v_cvt_pk_bf16_f32 v4, v44, v45
    v_lshlrev_b32 v44, 16, v4
    v_max_u32_dpp v62, v110, v110 row_ror:8 row_mask:0xf bank_mask:0xf
    v_and_b32 v45, 0xffff0000, v4
    v_pk_mul_f32 v[44:45], v[44:45], v[102:103] op_sel:[0,0] op_sel_hi:[1,0]
    v_cvt_pk_bf16_f32 v80, v44, v45
    v_max_u32_dpp v62, v62, v62 row_ror:4 row_mask:0xf bank_mask:0xf
    v_pk_add_f32 v[46:47], v[126:127], v[100:101] op_sel:[0,0] op_sel_hi:[1,0] neg_lo:[0,1] neg_hi:[0,1]
    v_cvt_pk_bf16_f32 v4, v46, v47
    v_lshlrev_b32 v46, 16, v4
    v_max_u32_dpp v62, v62, v62 row_ror:2 row_mask:0xf bank_mask:0xf
    v_and_b32 v47, 0xffff0000, v4
    v_pk_mul_f32 v[46:47], v[46:47], v[102:103] op_sel:[0,0] op_sel_hi:[1,0]
    v_cvt_pk_bf16_f32 v81, v46, v47
    v_max_u32_dpp v62, v62, v62 row_ror:1 row_mask:0xf bank_mask:0xf
    v_pk_add_f32 v[48:49], v[128:129], v[100:101] op_sel:[0,0] op_sel_hi:[1,0] neg_lo:[0,1] neg_hi:[0,1]
    v_cvt_pk_bf16_f32 v4, v48, v49
    v_lshlrev_b32 v48, 16, v4
    v_cmp_eq_u32 s[24:25], v62, v110
    v_and_b32 v49, 0xffff0000, v4
    v_pk_mul_f32 v[48:49], v[48:49], v[102:103] op_sel:[0,0] op_sel_hi:[1,0]
    v_cvt_pk_bf16_f32 v82, v48, v49
    v_cndmask_b32 v63, v110, 0, s[24:25]
    v_pk_add_f32 v[50:51], v[130:131], v[100:101] op_sel:[0,0] op_sel_hi:[1,0] neg_lo:[0,1] neg_hi:[0,1]
    v_cvt_pk_bf16_f32 v4, v50, v51
    v_lshlrev_b32 v50, 16, v4
    v_max_u32_dpp v64, v63, v63 row_ror:8 row_mask:0xf bank_mask:0xf
    v_and_b32 v51, 0xffff0000, v4
    v_pk_mul_f32 v[50:51], v[50:51], v[102:103] op_sel:[0,0] op_sel_hi:[1,0]
    v_cvt_pk_bf16_f32 v83, v50, v51
    v_max_u32_dpp v64, v64, v64 row_ror:4 row_mask:0xf bank_mask:0xf
    v_pk_add_f32 v[52:53], v[132:133], v[100:101] op_sel:[0,0] op_sel_hi:[1,0] neg_lo:[0,1] neg_hi:[0,1]
    v_cvt_pk_bf16_f32 v4, v52, v53
    v_lshlrev_b32 v52, 16, v4
    v_max_u32_dpp v64, v64, v64 row_ror:2 row_mask:0xf bank_mask:0xf
    v_and_b32 v53, 0xffff0000, v4
    v_pk_mul_f32 v[52:53], v[52:53], v[102:103] op_sel:[0,0] op_sel_hi:[1,0]
    v_cvt_pk_bf16_f32 v84, v52, v53
    v_max_u32_dpp v64, v64, v64 row_ror:1 row_mask:0xf bank_mask:0xf
    v_pk_add_f32 v[54:55], v[134:135], v[100:101] op_sel:[0,0] op_sel_hi:[1,0] neg_lo:[0,1] neg_hi:[0,1]
    v_cvt_pk_bf16_f32 v4, v54, v55
    v_lshlrev_b32 v54, 16, v4
    v_cmp_eq_u32 s[26:27], v64, v110
    v_and_b32 v55, 0xffff0000, v4
    v_pk_mul_f32 v[54:55], v[54:55], v[102:103] op_sel:[0,0] op_sel_hi:[1,0]
    v_cvt_pk_bf16_f32 v85, v54, v55
    v_mad_u32_u24 v4, v3, 24, s94
    v_add_u32 v5, 128, v4
    v_cndmask_b32 v4, v4, v5, s[26:27]
    s_or_b64 exec, s[24:25], s[26:27]
    ds_write_b64 v4, v[80:81] offset:0
    ds_write_b64 v4, v[82:83] offset:8
    ds_write_b64 v4, v[84:85] offset:16
    s_mov_b64 exec, 0x3f3f
    ds_read_b128 v[88:91], v138
    s_waitcnt lgkmcnt(0)
    v_max_u32 v88, 1, v88
    v_max_u32 v89, 1, v89
    v_max_u32 v90, 1, v90
    v_max_u32 v91, 1, v91
    buffer_store_dwordx4 v[88:91], v17, s[48:51], s30 offen sc1
    s_mov_b64 exec, -1
    s_setprio 0
    v_lshlrev_b32 v44, 16, v80
    v_and_b32 v45, 0xffff0000, v80
    v_pk_add_f32 v[44:45], v[44:45], v[124:125]
    v_cvt_pk_bf16_f32 v104, v44, v45
    v_lshlrev_b32 v46, 16, v81
    v_and_b32 v47, 0xffff0000, v81
    v_pk_add_f32 v[46:47], v[46:47], v[126:127]
    v_cvt_pk_bf16_f32 v105, v46, v47
    v_lshlrev_b32 v48, 16, v82
    v_and_b32 v49, 0xffff0000, v82
    v_pk_add_f32 v[48:49], v[48:49], v[128:129]
    v_cvt_pk_bf16_f32 v106, v48, v49
    v_lshlrev_b32 v50, 16, v83
    v_and_b32 v51, 0xffff0000, v83
    v_pk_add_f32 v[50:51], v[50:51], v[130:131]
    v_cvt_pk_bf16_f32 v107, v50, v51
    v_lshlrev_b32 v52, 16, v84
    v_and_b32 v53, 0xffff0000, v84
    v_pk_add_f32 v[52:53], v[52:53], v[132:133]
    v_cvt_pk_bf16_f32 v108, v52, v53
    v_lshlrev_b32 v54, 16, v85
    v_and_b32 v55, 0xffff0000, v85
    v_pk_add_f32 v[54:55], v[54:55], v[134:135]
    v_cvt_pk_bf16_f32 v109, v54, v55
    ds_write_b64 v16, v[104:105] offset:0
    ds_write_b64 v16, v[106:107] offset:8
    ds_write_b64 v16, v[108:109] offset:16
    s_lshl_b32 s14, s3, 6
    v_add_u32 v4, s14, v0
    v_mul_u32_u24 v20, 683, v4
    v_lshrrev_b32 v20, 13, v20
    v_mul_u32_u24 v5, 960, v20
    v_lshlrev_b32 v4, 4, v4
    v_add_u32 v22, v5, v4
    v_add_u32 v24, 147456, v4
    s_lshl_b32 s14, s3, 6
    s_add_u32 s14, s14, 512
    v_add_u32 v4, s14, v0
    v_mul_u32_u24 v21, 683, v4
    v_lshrrev_b32 v21, 13, v21
    v_mul_u32_u24 v5, 960, v21
    v_lshlrev_b32 v4, 4, v4
    v_add_u32 v23, v5, v4
    v_add_u32 v25, 147456, v4
    v_max_u32 v92, 1, v56
    v_max_u32 v93, 1, v57
    v_max_u32 v94, 1, v58
    v_max_u32 v95, 1, v59
    v_max_u32 v96, 1, v60
    v_max_u32 v97, 1, v61
    v_xor_b32 v4, s95, v71
    v_xor_b32 v5, s95, v75
    v_xor_b32 v6, s95, v79
    v_or3_b32 v4, v4, v5, v6
    v_and_b32 v4, 15, v4
    v_cmp_ne_u32 vcc, 0, v4
    s_cbranch_vccz L_B_nowt
    s_mov_b64 exec, 0xffff
    buffer_store_dwordx4 v[116:119], v11, s[48:51], s29 offen sc1
    s_mov_b64 exec, -1
L_B_nowt:
    s_lshl3_add_u32 s14, s5, s3
    s_mul_i32 s14, s14, 1536
    s_add_u32 s14, s14, 3932160
    v_lshlrev_b32 v4, 7, v0
    s_sleep 11
    s_mov_b64 exec, 0xfff
    buffer_load_dword v137, v4, s[48:51], s14 offen sc1
    s_mov_b64 exec, -1
    s_cmp_lg_u32 s3, 0
    s_cbranch_scc1 L_B_selskip
    s_mov_b32 s14, 3473408
    s_mov_b32 s38, 400000
    s_sleep 12
L_B_selpoll:
    buffer_load_dwordx4 v[36:39], v11, s[48:51], s14 offen sc1
    s_waitcnt vmcnt(0)
    v_min3_u32 v5, v36, v37, v38
    v_min_u32 v5, v5, v39
    v_cmp_eq_u32 vcc, 0, v5
    s_cbranch_vccz L_B_selok
    s_sleep 4
    s_sub_u32 s38, s38, 1
    s_cbranch_scc0 L_B_selpoll
L_B_selok:
    v_max_u32 v6, v36, v38
    v_max_u32 v7, v37, v39
    v_med3_u32 v7, v36, v7, v38
    v_min_u32_dpp v4, v6, v6 row_ror:8 row_mask:0xf bank_mask:0xf
    v_max_u32_dpp v6, v6, v6 row_ror:8 row_mask:0xf bank_mask:0xf
    v_max_u32_dpp v5, v7, v7 row_ror:8 row_mask:0xf bank_mask:0xf
    v_max_u32 v7, v4, v5
    v_min_u32_dpp v4, v6, v6 row_ror:4 row_mask:0xf bank_mask:0xf
    v_max_u32_dpp v6, v6, v6 row_ror:4 row_mask:0xf bank_mask:0xf
    v_max_u32_dpp v5, v7, v7 row_ror:4 row_mask:0xf bank_mask:0xf
    v_max_u32 v7, v4, v5
    v_min_u32_dpp v4, v6, v6 row_ror:2 row_mask:0xf bank_mask:0xf
    v_max_u32_dpp v6, v6, v6 row_ror:2 row_mask:0xf bank_mask:0xf
    v_max_u32_dpp v5, v7, v7 row_ror:2 row_mask:0xf bank_mask:0xf
    v_max_u32 v7, v4, v5
    v_min_u32_dpp v4, v6, v6 row_ror:1 row_mask:0xf bank_mask:0xf
    v_max_u32_dpp v6, v6, v6 row_ror:1 row_mask:0xf bank_mask:0xf
    v_max_u32_dpp v5, v7, v7 row_ror:1 row_mask:0xf bank_mask:0xf
    v_max_u32 v7, v4, v5
    v_mov_b32 v4, v6
    v_mov_b32 v5, v7
    s_nop 0
    v_permlane16_swap_b32 v6, v4
    v_permlane16_swap_b32 v7, v5
    v_max_u32 v7, v7, v5
    v_med3_u32 v7, v6, v7, v4
    v_max_u32 v6, v6, v4
    v_mov_b32 v4, v6
    v_mov_b32 v5, v7
    s_nop 0
    v_permlane32_swap_b32 v6, v4
    v_permlane32_swap_b32 v7, v5
    v_max_u32 v7, v7, v5
    v_med3_u32 v7, v6, v7, v4
    v_max_u32 v6, v6, v4
    v_mov_b32 v4, 0
    ds_write_b64 v4, v[6:7]
L_B_selskip:
    s_waitcnt lgkmcnt(0)
    s_barrier
    v_mov_b32 v4, 0
    ds_read_b64 v[6:7], v4
    ds_read_b128 v[28:31], v24
    ds_read_b128 v[32:35], v25
    s_lshl_b32 s14, s11, 6
    s_sub_u32 s14, 0x7ff, s14
    s_mul_i32 s15, s11, 73728
    s_mul_i32 s19, s12, 192
    s_add_u32 s15, s15, s19
    s_mul_i32 s16, s31, 96
    s_add_u32 s16, s16, 4523008
    v_mul_u32_u24 v4, 24, v3
    v_add_u32 v5, 1152, v4
    s_waitcnt lgkmcnt(0)
    v_cmp_eq_u32 vcc, v7, v110
    v_cmp_eq_u32 s[24:25], v6, v110
    s_nop 0
    v_cndmask_b32 v4, v4, v5, vcc
    s_or_b64 exec, vcc, s[24:25]
    s_cbranch_execz L_B_noh
    buffer_store_dwordx4 v[92:95], v4, s[48:51], s16 offen sc1
    buffer_store_dwordx2 v[96:97], v4, s[48:51], s16 offen offset:16 sc1
L_B_noh:
    s_mov_b64 exec, -1
    v_and_b32 v6, 0x7ff, v6
    v_and_b32 v7, 0x7ff, v7
    v_sub_u32 v4, s14, v20
    v_cmp_ne_u32 vcc, v4, v6
    v_cmp_ne_u32 s[24:25], v4, v7
    s_nop 0
    s_and_b64 exec, vcc, s[24:25]
    buffer_store_dwordx4 v[28:31], v22, s[60:63], s15 offen sc1
    s_mov_b64 exec, -1
    s_cmp_ge_u32 s3, 4
    s_cbranch_scc1 L_B_end
    v_sub_u32 v4, s14, v21
    v_cmp_ne_u32 vcc, v4, v6
    v_cmp_ne_u32 s[24:25], v4, v7
    s_nop 0
    s_and_b64 exec, vcc, s[24:25]
    buffer_store_dwordx4 v[32:35], v23, s[60:63], s15 offen sc1
    s_mov_b64 exec, -1
L_B_end:
    s_endpgm
L_B_h1other:
    s_setprio 0
    v_lshlrev_b32 v124, 16, v56
    v_and_b32 v125, 0xffff0000, v56
    v_lshlrev_b32 v126, 16, v57
    v_and_b32 v127, 0xffff0000, v57
    v_lshlrev_b32 v128, 16, v58
    v_and_b32 v129, 0xffff0000, v58
    v_lshlrev_b32 v130, 16, v59
    v_and_b32 v131, 0xffff0000, v59
    v_lshlrev_b32 v132, 16, v60
    v_and_b32 v133, 0xffff0000, v60
    v_lshlrev_b32 v134, 16, v61
    v_and_b32 v135, 0xffff0000, v61
L_B_h1polla:
    buffer_load_dwordx4 v[68:71], v143, s[48:51], s28 offen offset:0 sc1
    buffer_load_dwordx4 v[72:75], v143, s[48:51], s28 offen offset:256 sc1
    buffer_load_dwordx4 v[76:79], v143, s[48:51], s28 offen offset:512 sc1
    s_waitcnt vmcnt(0)
    v_min3_u32 v4, v68, v69, v70
    v_min3_u32 v5, v71, v72, v73
    v_min3_u32 v4, v4, v74, v75
    v_min3_u32 v5, v5, v76, v77
    v_min3_u32 v4, v4, v78, v79
    v_min_u32 v4, v4, v5
    v_cmp_eq_u32 vcc, 0, v4
    s_cbranch_vccz L_B_h1oka
    s_cmp_lg_u32 s38, 399988
    s_cbranch_scc1 L_B_h1nosta
    s_mov_b64 exec, 0xffff
    buffer_store_dwordx4 v[116:119], v11, s[48:51], s29 offen sc1
    s_mov_b64 exec, -1
L_B_h1nosta:
    s_sleep 2
    s_sub_u32 s38, s38, 1
    s_cbranch_scc0 L_B_h1polla
L_B_h1oka:
    s_setprio 1
    s_branch L_B_h1okb
L_B_kvretry:
    s_sub_u32 s38, s38, 1
    s_cbranch_scc1 L_B_kvok
    s_sleep 1
    buffer_load_dwordx4 v11, s[48:51], s23 offen offset:0 sc1 lds
    buffer_load_dwordx4 v11, s[48:51], s23 offen offset:1024 sc1 lds
    buffer_load_dwordx4 v11, s[48:51], s23 offen offset:2048 sc1 lds
    buffer_load_dwordx4 v11, s[48:51], s23 offen offset:3072 sc1 lds
    s_waitcnt vmcnt(0)
    s_branch L_B_kvchk
L_helper:
    s_sub_u32 s6, s5, 24
    s_and_b32 s14, s4, 3
    s_lshr_b32 s15, s4, 2
    s_lshl4_add_u32 s83, s14, s6
    s_xor_b32 s84, s15, 1
    s_lshl3_add_u32 s83, s84, s83
    s_lshl2_add_u32 s14, s6, s14
    s_lshl1_add_u32 s85, s15, s14
    s_cmp_lt_u32 s85, 10
    s_cselect_b32 s84, 18, 26
    s_mov_b32 s85, 10
    s_cmp_ge_u32 s14, 18
    s_cselect_b32 s84, -18, s84
    s_cselect_b32 s85, 9, s85
    s_cmp_ge_u32 s14, 27
    s_cselect_b32 s84, 27, s84
    s_cselect_b32 s85, 5, s85
    s_mul_i32 s85, s85, s15
    s_add_u32 s84, s84, s14
    s_add_u32 s84, s84, s85
    s_lshl3_add_u32 s6, s4, s6
    s_and_b32 s8, s3, 3
    s_lshl2_add_u32 s7, s6, s8
    v_lshlrev_b32 v11, 4, v0
    s_cmp_lt_u32 s3, 4
    s_cbranch_scc1 L_H_lo
    v_lshrrev_b32 v4, 3, v0
    v_and_b32 v5, 7, v0
    v_lshlrev_b32 v5, 4, v5
    v_mul_u32_u24 v6, 1152, v4
    v_add_u32 v6, v6, v5
    s_lshl2_add_u32 s14, s83, s8
    s_mul_i32 s14, s14, 9216
    s_waitcnt lgkmcnt(0)
    s_mov_b32 s40, s16
    s_mov_b32 s41, s17
    s_mov_b32 s42, 2359296
    s_mov_b32 s43, 0x20000
    s_mov_b32 s86, s14
    buffer_load_dwordx4 v[16:19], v6, s[40:43], s86 offen offset:0
    buffer_load_dwordx4 v[20:23], v6, s[40:43], s86 offen offset:128
    buffer_load_dwordx4 v[24:27], v6, s[40:43], s86 offen offset:256
    buffer_load_dwordx4 v[28:31], v6, s[40:43], s86 offen offset:384
    buffer_load_dwordx4 v[32:35], v6, s[40:43], s86 offen offset:512
    buffer_load_dwordx4 v[36:39], v6, s[40:43], s86 offen offset:640
    buffer_load_dwordx4 v[40:43], v6, s[40:43], s86 offen offset:768
    buffer_load_dwordx4 v[44:47], v6, s[40:43], s86 offen offset:896
    buffer_load_dwordx4 v[48:51], v6, s[40:43], s86 offen offset:1024
    s_mov_b32 s44, s18
    s_mov_b32 s45, s19
    s_mov_b32 s46, 1990656
    s_mov_b32 s47, 0x20000
    v_mul_u32_u24 v7, 3456, v4
    v_add_u32 v7, v7, v5
    s_lshr_b32 s15, s84, 1
    s_min_u32 s15, s15, 26
    s_lshl_b32 s15, s15, 7
    s_lshl2_add_u32 s14, s84, s8
    s_and_b32 s14, s14, 7
    s_mul_i32 s14, s14, 248832
    s_add_u32 s14, s14, s15
    buffer_load_dwordx4 v[72:75], v7, s[44:47], s14 offen
    s_add_u32 s14, s14, 27648
    buffer_load_dwordx4 v[76:79], v7, s[44:47], s14 offen
    s_add_u32 s14, s14, 27648
    buffer_load_dwordx4 v[80:83], v7, s[44:47], s14 offen
    s_add_u32 s14, s14, 27648
    buffer_load_dwordx4 v[84:87], v7, s[44:47], s14 offen
    s_add_u32 s14, s14, 27648
    buffer_load_dwordx4 v[88:91], v7, s[44:47], s14 offen
    s_add_u32 s14, s14, 27648
    buffer_load_dwordx4 v[92:95], v7, s[44:47], s14 offen
    s_add_u32 s14, s14, 27648
    buffer_load_dwordx4 v[96:99], v7, s[44:47], s14 offen
    s_add_u32 s14, s14, 27648
    buffer_load_dwordx4 v[100:103], v7, s[44:47], s14 offen
    s_add_u32 s14, s14, 27648
    buffer_load_dwordx4 v[104:107], v7, s[44:47], s14 offen
    s_barrier
    s_setprio 3
    s_mov_b32 s48, s36
    s_mov_b32 s49, s37
    s_mov_b32 s50, 4526080
    s_mov_b32 s51, 0x20000
    s_mov_b32 s76, s30
    s_mov_b32 s77, s31
    s_mov_b32 s78, 5308416
    s_mov_b32 s79, 0x20000
    v_mov_b32 v252, 163200
    v_mov_b32 v253, 1
    v_mov_b32 v12, 0
    v_mov_b32 v13, 0
    v_mov_b32 v14, 0
    v_mov_b32 v15, 0
    v_lshlrev_b32 v6, 2, v4
    s_lshl_b32 s12, s83, 9
    s_lshl_b32 s13, s84, 9
    s_add_u32 s13, s13, 3498240
    s_lshl_b32 s14, s8, 5
    s_add_u32 s12, s12, s14
    s_add_u32 s12, s12, 3497984
    s_waitcnt vmcnt(17)
    v_lshlrev_b32 v56, 16, v16
    v_and_b32 v57, 0xffff0000, v16
    v_pk_mul_f32 v[68:69], v[56:57], v[56:57]
    v_pk_add_f32 v[64:65], v[56:57], 0
    v_lshlrev_b32 v58, 16, v17
    v_and_b32 v59, 0xffff0000, v17
    v_pk_mul_f32 v[70:71], v[58:59], v[58:59]
    v_pk_add_f32 v[66:67], v[58:59], 0
    v_lshlrev_b32 v60, 16, v18
    v_and_b32 v61, 0xffff0000, v18
    v_pk_fma_f32 v[68:69], v[60:61], v[60:61], v[68:69]
    v_pk_add_f32 v[64:65], v[64:65], v[60:61]
    v_lshlrev_b32 v62, 16, v19
    v_and_b32 v63, 0xffff0000, v19
    v_pk_fma_f32 v[70:71], v[62:63], v[62:63], v[70:71]
    v_pk_add_f32 v[66:67], v[66:67], v[62:63]
    s_waitcnt vmcnt(16)
    v_lshlrev_b32 v56, 16, v20
    v_and_b32 v57, 0xffff0000, v20
    v_pk_fma_f32 v[68:69], v[56:57], v[56:57], v[68:69]
    v_pk_add_f32 v[64:65], v[64:65], v[56:57]
    v_lshlrev_b32 v58, 16, v21
    v_and_b32 v59, 0xffff0000, v21
    v_pk_fma_f32 v[70:71], v[58:59], v[58:59], v[70:71]
    v_pk_add_f32 v[66:67], v[66:67], v[58:59]
    v_lshlrev_b32 v60, 16, v22
    v_and_b32 v61, 0xffff0000, v22
    v_pk_fma_f32 v[68:69], v[60:61], v[60:61], v[68:69]
    v_pk_add_f32 v[64:65], v[64:65], v[60:61]
    v_lshlrev_b32 v62, 16, v23
    v_and_b32 v63, 0xffff0000, v23
    v_pk_fma_f32 v[70:71], v[62:63], v[62:63], v[70:71]
    v_pk_add_f32 v[66:67], v[66:67], v[62:63]
    s_waitcnt vmcnt(15)
    v_lshlrev_b32 v56, 16, v24
    v_and_b32 v57, 0xffff0000, v24
    v_pk_fma_f32 v[68:69], v[56:57], v[56:57], v[68:69]
    v_pk_add_f32 v[64:65], v[64:65], v[56:57]
    v_lshlrev_b32 v58, 16, v25
    v_and_b32 v59, 0xffff0000, v25
    v_pk_fma_f32 v[70:71], v[58:59], v[58:59], v[70:71]
    v_pk_add_f32 v[66:67], v[66:67], v[58:59]
    v_lshlrev_b32 v60, 16, v26
    v_and_b32 v61, 0xffff0000, v26
    v_pk_fma_f32 v[68:69], v[60:61], v[60:61], v[68:69]
    v_pk_add_f32 v[64:65], v[64:65], v[60:61]
    v_lshlrev_b32 v62, 16, v27
    v_and_b32 v63, 0xffff0000, v27
    v_pk_fma_f32 v[70:71], v[62:63], v[62:63], v[70:71]
    v_pk_add_f32 v[66:67], v[66:67], v[62:63]
    s_waitcnt vmcnt(14)
    v_lshlrev_b32 v56, 16, v28
    v_and_b32 v57, 0xffff0000, v28
    v_pk_fma_f32 v[68:69], v[56:57], v[56:57], v[68:69]
    v_pk_add_f32 v[64:65], v[64:65], v[56:57]
    v_lshlrev_b32 v58, 16, v29
    v_and_b32 v59, 0xffff0000, v29
    v_pk_fma_f32 v[70:71], v[58:59], v[58:59], v[70:71]
    v_pk_add_f32 v[66:67], v[66:67], v[58:59]
    v_lshlrev_b32 v60, 16, v30
    v_and_b32 v61, 0xffff0000, v30
    v_pk_fma_f32 v[68:69], v[60:61], v[60:61], v[68:69]
    v_pk_add_f32 v[64:65], v[64:65], v[60:61]
    v_lshlrev_b32 v62, 16, v31
    v_and_b32 v63, 0xffff0000, v31
    v_pk_fma_f32 v[70:71], v[62:63], v[62:63], v[70:71]
    v_pk_add_f32 v[66:67], v[66:67], v[62:63]
    s_waitcnt vmcnt(13)
    v_lshlrev_b32 v56, 16, v32
    v_and_b32 v57, 0xffff0000, v32
    v_pk_fma_f32 v[68:69], v[56:57], v[56:57], v[68:69]
    v_pk_add_f32 v[64:65], v[64:65], v[56:57]
    v_lshlrev_b32 v58, 16, v33
    v_and_b32 v59, 0xffff0000, v33
    v_pk_fma_f32 v[70:71], v[58:59], v[58:59], v[70:71]
    v_pk_add_f32 v[66:67], v[66:67], v[58:59]
    v_lshlrev_b32 v60, 16, v34
    v_and_b32 v61, 0xffff0000, v34
    v_pk_fma_f32 v[68:69], v[60:61], v[60:61], v[68:69]
    v_pk_add_f32 v[64:65], v[64:65], v[60:61]
    v_lshlrev_b32 v62, 16, v35
    v_and_b32 v63, 0xffff0000, v35
    v_pk_fma_f32 v[70:71], v[62:63], v[62:63], v[70:71]
    v_pk_add_f32 v[66:67], v[66:67], v[62:63]
    s_waitcnt vmcnt(12)
    v_lshlrev_b32 v56, 16, v36
    v_and_b32 v57, 0xffff0000, v36
    v_pk_fma_f32 v[68:69], v[56:57], v[56:57], v[68:69]
    v_pk_add_f32 v[64:65], v[64:65], v[56:57]
    v_lshlrev_b32 v58, 16, v37
    v_and_b32 v59, 0xffff0000, v37
    v_pk_fma_f32 v[70:71], v[58:59], v[58:59], v[70:71]
    v_pk_add_f32 v[66:67], v[66:67], v[58:59]
    v_lshlrev_b32 v60, 16, v38
    v_and_b32 v61, 0xffff0000, v38
    v_pk_fma_f32 v[68:69], v[60:61], v[60:61], v[68:69]
    v_pk_add_f32 v[64:65], v[64:65], v[60:61]
    v_lshlrev_b32 v62, 16, v39
    v_and_b32 v63, 0xffff0000, v39
    v_pk_fma_f32 v[70:71], v[62:63], v[62:63], v[70:71]
    v_pk_add_f32 v[66:67], v[66:67], v[62:63]
    s_waitcnt vmcnt(11)
    v_lshlrev_b32 v56, 16, v40
    v_and_b32 v57, 0xffff0000, v40
    v_pk_fma_f32 v[68:69], v[56:57], v[56:57], v[68:69]
    v_pk_add_f32 v[64:65], v[64:65], v[56:57]
    v_lshlrev_b32 v58, 16, v41
    v_and_b32 v59, 0xffff0000, v41
    v_pk_fma_f32 v[70:71], v[58:59], v[58:59], v[70:71]
    v_pk_add_f32 v[66:67], v[66:67], v[58:59]
    v_lshlrev_b32 v60, 16, v42
    v_and_b32 v61, 0xffff0000, v42
    v_pk_fma_f32 v[68:69], v[60:61], v[60:61], v[68:69]
    v_pk_add_f32 v[64:65], v[64:65], v[60:61]
    v_lshlrev_b32 v62, 16, v43
    v_and_b32 v63, 0xffff0000, v43
    v_pk_fma_f32 v[70:71], v[62:63], v[62:63], v[70:71]
    v_pk_add_f32 v[66:67], v[66:67], v[62:63]
    s_waitcnt vmcnt(10)
    v_lshlrev_b32 v56, 16, v44
    v_and_b32 v57, 0xffff0000, v44
    v_pk_fma_f32 v[68:69], v[56:57], v[56:57], v[68:69]
    v_pk_add_f32 v[64:65], v[64:65], v[56:57]
    v_lshlrev_b32 v58, 16, v45
    v_and_b32 v59, 0xffff0000, v45
    v_pk_fma_f32 v[70:71], v[58:59], v[58:59], v[70:71]
    v_pk_add_f32 v[66:67], v[66:67], v[58:59]
    v_lshlrev_b32 v60, 16, v46
    v_and_b32 v61, 0xffff0000, v46
    v_pk_fma_f32 v[68:69], v[60:61], v[60:61], v[68:69]
    v_pk_add_f32 v[64:65], v[64:65], v[60:61]
    v_lshlrev_b32 v62, 16, v47
    v_and_b32 v63, 0xffff0000, v47
    v_pk_fma_f32 v[70:71], v[62:63], v[62:63], v[70:71]
    v_pk_add_f32 v[66:67], v[66:67], v[62:63]
    s_waitcnt vmcnt(9)
    v_lshlrev_b32 v56, 16, v48
    v_and_b32 v57, 0xffff0000, v48
    v_pk_fma_f32 v[68:69], v[56:57], v[56:57], v[68:69]
    v_pk_add_f32 v[64:65], v[64:65], v[56:57]
    v_lshlrev_b32 v58, 16, v49
    v_and_b32 v59, 0xffff0000, v49
    v_pk_fma_f32 v[70:71], v[58:59], v[58:59], v[70:71]
    v_pk_add_f32 v[66:67], v[66:67], v[58:59]
    v_lshlrev_b32 v60, 16, v50
    v_and_b32 v61, 0xffff0000, v50
    v_pk_fma_f32 v[68:69], v[60:61], v[60:61], v[68:69]
    v_pk_add_f32 v[64:65], v[64:65], v[60:61]
    v_lshlrev_b32 v62, 16, v51
    v_and_b32 v63, 0xffff0000, v51
    v_pk_fma_f32 v[70:71], v[62:63], v[62:63], v[70:71]
    v_pk_add_f32 v[66:67], v[66:67], v[62:63]
    v_pk_add_f32 v[64:65], v[64:65], v[66:67]
    v_pk_add_f32 v[68:69], v[68:69], v[70:71]
    v_add_f32 v64, v64, v65
    v_add_f32 v68, v68, v69
    s_nop 0
    v_add_f32_dpp v64, v64, v64 quad_perm:[1,0,3,2] row_mask:0xf bank_mask:0xf
    v_add_f32_dpp v68, v68, v68 quad_perm:[1,0,3,2] row_mask:0xf bank_mask:0xf
    s_nop 0
    v_add_f32_dpp v64, v64, v64 quad_perm:[2,3,0,1] row_mask:0xf bank_mask:0xf
    v_add_f32_dpp v68, v68, v68 quad_perm:[2,3,0,1] row_mask:0xf bank_mask:0xf
    s_nop 0
    v_add_f32_dpp v64, v64, v64 row_half_mirror row_mask:0xf bank_mask:0xf
    v_add_f32_dpp v68, v68, v68 row_half_mirror row_mask:0xf bank_mask:0xf
    v_mul_f32 v65, 0x3ae38e39, v64
    v_mul_f32 v67, v65, v65
    s_mov_b32 s14, 0x3ae38e39
    v_fma_f32 v67, v68, s14, -v67
    v_max_f32 v67, 0, v67
    v_cvt_pk_bf16_f32 v67, v65, v67
    v_lshlrev_b32 v65, 16, v67
    v_and_b32 v67, 0xffff0000, v67
    v_add_f32 v67, 0x3727c5ac, v67
    v_cvt_pk_bf16_f32 v67, v67, v67
    v_lshlrev_b32 v67, 16, v67
    v_sqrt_f32 v67, v67
    s_nop 0
    v_cvt_pk_bf16_f32 v67, v67, v67
    v_lshlrev_b32 v67, 16, v67
    v_rcp_f32 v66, v67
    s_nop 0
    v_mul_f32 v65, v65, v66
    v_xor_b32 v65, 0x80000000, v65
    v_max_u32 v66, 1, v66
    v_max_u32 v65, 1, v65
    s_waitcnt vmcnt(8)
    v_lshlrev_b32 v16, 16, v72
    v_and_b32 v17, 0xffff0000, v72
    v_lshlrev_b32 v18, 16, v73
    v_and_b32 v19, 0xffff0000, v73
    v_lshlrev_b32 v20, 16, v74
    v_and_b32 v21, 0xffff0000, v74
    v_lshlrev_b32 v22, 16, v75
    v_and_b32 v23, 0xffff0000, v75
    s_waitcnt vmcnt(7)
    v_lshlrev_b32 v56, 16, v76
    v_and_b32 v57, 0xffff0000, v76
    v_pk_add_f32 v[16:17], v[16:17], v[56:57]
    v_lshlrev_b32 v58, 16, v77
    v_and_b32 v59, 0xffff0000, v77
    v_pk_add_f32 v[18:19], v[18:19], v[58:59]
    v_lshlrev_b32 v60, 16, v78
    v_and_b32 v61, 0xffff0000, v78
    v_pk_add_f32 v[20:21], v[20:21], v[60:61]
    v_lshlrev_b32 v62, 16, v79
    v_and_b32 v63, 0xffff0000, v79
    v_pk_add_f32 v[22:23], v[22:23], v[62:63]
    s_waitcnt vmcnt(6)
    v_lshlrev_b32 v56, 16, v80
    v_and_b32 v57, 0xffff0000, v80
    v_pk_add_f32 v[16:17], v[16:17], v[56:57]
    v_lshlrev_b32 v58, 16, v81
    v_and_b32 v59, 0xffff0000, v81
    v_pk_add_f32 v[18:19], v[18:19], v[58:59]
    v_lshlrev_b32 v60, 16, v82
    v_and_b32 v61, 0xffff0000, v82
    v_pk_add_f32 v[20:21], v[20:21], v[60:61]
    v_lshlrev_b32 v62, 16, v83
    v_and_b32 v63, 0xffff0000, v83
    v_pk_add_f32 v[22:23], v[22:23], v[62:63]
    s_waitcnt vmcnt(5)
    v_lshlrev_b32 v56, 16, v84
    v_and_b32 v57, 0xffff0000, v84
    v_pk_add_f32 v[16:17], v[16:17], v[56:57]
    v_lshlrev_b32 v58, 16, v85
    v_and_b32 v59, 0xffff0000, v85
    v_pk_add_f32 v[18:19], v[18:19], v[58:59]
    v_lshlrev_b32 v60, 16, v86
    v_and_b32 v61, 0xffff0000, v86
    v_pk_add_f32 v[20:21], v[20:21], v[60:61]
    v_lshlrev_b32 v62, 16, v87
    v_and_b32 v63, 0xffff0000, v87
    v_pk_add_f32 v[22:23], v[22:23], v[62:63]
    s_waitcnt vmcnt(4)
    v_lshlrev_b32 v56, 16, v88
    v_and_b32 v57, 0xffff0000, v88
    v_pk_add_f32 v[16:17], v[16:17], v[56:57]
    v_lshlrev_b32 v58, 16, v89
    v_and_b32 v59, 0xffff0000, v89
    v_pk_add_f32 v[18:19], v[18:19], v[58:59]
    v_lshlrev_b32 v60, 16, v90
    v_and_b32 v61, 0xffff0000, v90
    v_pk_add_f32 v[20:21], v[20:21], v[60:61]
    v_lshlrev_b32 v62, 16, v91
    v_and_b32 v63, 0xffff0000, v91
    v_pk_add_f32 v[22:23], v[22:23], v[62:63]
    s_waitcnt vmcnt(3)
    v_lshlrev_b32 v56, 16, v92
    v_and_b32 v57, 0xffff0000, v92
    v_pk_add_f32 v[16:17], v[16:17], v[56:57]
    v_lshlrev_b32 v58, 16, v93
    v_and_b32 v59, 0xffff0000, v93
    v_pk_add_f32 v[18:19], v[18:19], v[58:59]
    v_lshlrev_b32 v60, 16, v94
    v_and_b32 v61, 0xffff0000, v94
    v_pk_add_f32 v[20:21], v[20:21], v[60:61]
    v_lshlrev_b32 v62, 16, v95
    v_and_b32 v63, 0xffff0000, v95
    v_pk_add_f32 v[22:23], v[22:23], v[62:63]
    s_waitcnt vmcnt(2)
    v_lshlrev_b32 v56, 16, v96
    v_and_b32 v57, 0xffff0000, v96
    v_pk_add_f32 v[16:17], v[16:17], v[56:57]
    v_lshlrev_b32 v58, 16, v97
    v_and_b32 v59, 0xffff0000, v97
    v_pk_add_f32 v[18:19], v[18:19], v[58:59]
    v_lshlrev_b32 v60, 16, v98
    v_and_b32 v61, 0xffff0000, v98
    v_pk_add_f32 v[20:21], v[20:21], v[60:61]
    v_lshlrev_b32 v62, 16, v99
    v_and_b32 v63, 0xffff0000, v99
    v_pk_add_f32 v[22:23], v[22:23], v[62:63]
    s_waitcnt vmcnt(1)
    v_lshlrev_b32 v56, 16, v100
    v_and_b32 v57, 0xffff0000, v100
    v_pk_add_f32 v[16:17], v[16:17], v[56:57]
    v_lshlrev_b32 v58, 16, v101
    v_and_b32 v59, 0xffff0000, v101
    v_pk_add_f32 v[18:19], v[18:19], v[58:59]
    v_lshlrev_b32 v60, 16, v102
    v_and_b32 v61, 0xffff0000, v102
    v_pk_add_f32 v[20:21], v[20:21], v[60:61]
    v_lshlrev_b32 v62, 16, v103
    v_and_b32 v63, 0xffff0000, v103
    v_pk_add_f32 v[22:23], v[22:23], v[62:63]
    s_waitcnt vmcnt(0)
    v_lshlrev_b32 v56, 16, v104
    v_and_b32 v57, 0xffff0000, v104
    v_pk_add_f32 v[16:17], v[16:17], v[56:57]
    v_lshlrev_b32 v58, 16, v105
    v_and_b32 v59, 0xffff0000, v105
    v_pk_add_f32 v[18:19], v[18:19], v[58:59]
    v_lshlrev_b32 v60, 16, v106
    v_and_b32 v61, 0xffff0000, v106
    v_pk_add_f32 v[20:21], v[20:21], v[60:61]
    v_lshlrev_b32 v62, 16, v107
    v_and_b32 v63, 0xffff0000, v107
    v_pk_add_f32 v[22:23], v[22:23], v[62:63]
    v_permlane16_swap_b32 v16, v17
    v_permlane16_swap_b32 v18, v19
    v_add_f32 v16, v16, v17
    v_add_f32 v18, v18, v19
    s_nop 1
    v_permlane32_swap_b32 v16, v18
    v_add_f32 v16, v16, v18
    v_permlane16_swap_b32 v20, v21
    v_permlane16_swap_b32 v22, v23
    v_add_f32 v20, v20, v21
    v_add_f32 v22, v22, v23
    s_nop 1
    v_permlane32_swap_b32 v20, v22
    v_add_f32 v20, v20, v22
    v_add_f32_dpp v16, v16, v16 row_ror:8 row_mask:0xf bank_mask:0xf
    s_nop 0
    v_add_f32_dpp v20, v20, v20 row_ror:8 row_mask:0xf bank_mask:0xf
    s_lshl_b32 s14, s8, 8
    s_add_u32 s14, s14, 148480
    v_lshl_add_u32 v7, v5, 1, s14
    v_lshl_add_u32 v7, v3, 2, v7
    ds_write_b32 v7, v16
    ds_write_b32 v7, v20 offset:16
    s_mov_b64 exec, 1
    ds_add_u32 v252, v253 offset:4
    s_mov_b64 exec, -1
    s_mov_b32 s38, 1600000
L_cw_21:
    ds_read_b32 v1, v252 offset:0
    s_waitcnt lgkmcnt(0)
    v_readfirstlane_b32 s14, v1
    s_nop 0
    s_cmp_ge_u32 s14, 4
    s_cbranch_scc1 L_cok_22
    s_sub_u32 s38, s38, 1
    s_cbranch_scc0 L_cw_21
L_cok_22:
    s_mov_b32 exec_lo, 0x01010101
    s_mov_b32 exec_hi, 0x01010101
    buffer_store_dword v66, v6, s[48:51], s12 offen sc1
    buffer_store_dword v65, v6, s[48:51], s12 offen offset:128 sc1
    s_mov_b64 exec, -1
    s_cmp_lg_u32 s3, 4
    s_cbranch_scc1 L_H_nocs
    v_lshlrev_b32 v6, 2, v0
    v_add_u32 v7, 148480, v6
    s_mov_b32 s38, 1600000
L_cw_23:
    ds_read_b32 v1, v252 offset:4
    s_waitcnt lgkmcnt(0)
    v_readfirstlane_b32 s14, v1
    s_nop 0
    s_cmp_ge_u32 s14, 4
    s_cbranch_scc1 L_cok_24
    s_sub_u32 s38, s38, 1
    s_cbranch_scc0 L_cw_23
L_cok_24:
    ds_read_b32 v56, v7 offset:0
    ds_read_b32 v57, v7 offset:256
    ds_read_b32 v58, v7 offset:512
    ds_read_b32 v59, v7 offset:768
    s_waitcnt lgkmcnt(0)
    v_add_f32 v56, v56, v57
    v_add_f32 v56, v56, v58
    v_add_f32 v56, v56, v59
    v_max_u32 v56, 1, v56
    buffer_store_dword v56, v6, s[48:51], s13 offen sc1
L_H_nocs:
L_H_task_done:
    s_setprio 0
    s_movk_i32 s14, 1152
    s_movk_i32 s15, -18
    v_add_u32 v1, 0, v0
    v_mul_u32_u24 v8, 911, v1
    v_lshrrev_b32 v8, 14, v8
    v_mad_i32_i24 v1, v8, s15, v1
    v_and_b32 v9, 3, v8
    v_and_b32 v10, 12, v8
    v_lshl_add_u32 v9, v10, 1, v9
    v_bfe_u32 v10, v8, 4, 1
    v_lshl_add_u32 v9, v10, 2, v9
    v_lshlrev_b32 v1, 4, v1
    v_mad_u32_u24 v240, v9, s14, v1
    v_add_u32 v1, 64, v0
    v_mul_u32_u24 v8, 911, v1
    v_lshrrev_b32 v8, 14, v8
    v_mad_i32_i24 v1, v8, s15, v1
    v_and_b32 v9, 3, v8
    v_and_b32 v10, 12, v8
    v_lshl_add_u32 v9, v10, 1, v9
    v_bfe_u32 v10, v8, 4, 1
    v_lshl_add_u32 v9, v10, 2, v9
    v_lshlrev_b32 v1, 4, v1
    v_mad_u32_u24 v241, v9, s14, v1
    v_add_u32 v1, 128, v0
    v_mul_u32_u24 v8, 911, v1
    v_lshrrev_b32 v8, 14, v8
    v_mad_i32_i24 v1, v8, s15, v1
    v_and_b32 v9, 3, v8
    v_and_b32 v10, 12, v8
    v_lshl_add_u32 v9, v10, 1, v9
    v_bfe_u32 v10, v8, 4, 1
    v_lshl_add_u32 v9, v10, 2, v9
    v_lshlrev_b32 v1, 4, v1
    v_mad_u32_u24 v242, v9, s14, v1
    v_add_u32 v1, 192, v0
    v_mul_u32_u24 v8, 911, v1
    v_lshrrev_b32 v8, 14, v8
    v_mad_i32_i24 v1, v8, s15, v1
    v_and_b32 v9, 3, v8
    v_and_b32 v10, 12, v8
    v_lshl_add_u32 v9, v10, 1, v9
    v_bfe_u32 v10, v8, 4, 1
    v_lshl_add_u32 v9, v10, 2, v9
    v_lshlrev_b32 v1, 4, v1
    v_mad_u32_u24 v243, v9, s14, v1
    v_add_u32 v1, 256, v0
    v_mul_u32_u24 v8, 911, v1
    v_lshrrev_b32 v8, 14, v8
    v_mad_i32_i24 v1, v8, s15, v1
    v_and_b32 v9, 3, v8
    v_and_b32 v10, 12, v8
    v_lshl_add_u32 v9, v10, 1, v9
    v_bfe_u32 v10, v8, 4, 1
    v_lshl_add_u32 v9, v10, 2, v9
    v_lshlrev_b32 v1, 4, v1
    v_mad_u32_u24 v244, v9, s14, v1
    v_add_u32 v1, 320, v0
    v_mul_u32_u24 v8, 911, v1
    v_lshrrev_b32 v8, 14, v8
    v_mad_i32_i24 v1, v8, s15, v1
    v_and_b32 v9, 3, v8
    v_and_b32 v10, 12, v8
    v_lshl_add_u32 v9, v10, 1, v9
    v_bfe_u32 v10, v8, 4, 1
    v_lshl_add_u32 v9, v10, 2, v9
    v_lshlrev_b32 v1, 4, v1
    v_mad_u32_u24 v245, v9, s14, v1
    v_add_u32 v1, 384, v0
    v_mul_u32_u24 v8, 911, v1
    v_lshrrev_b32 v8, 14, v8
    v_mad_i32_i24 v1, v8, s15, v1
    v_and_b32 v9, 3, v8
    v_and_b32 v10, 12, v8
    v_lshl_add_u32 v9, v10, 1, v9
    v_bfe_u32 v10, v8, 4, 1
    v_lshl_add_u32 v9, v10, 2, v9
    v_lshlrev_b32 v1, 4, v1
    v_mad_u32_u24 v246, v9, s14, v1
    v_add_u32 v1, 448, v0
    v_mul_u32_u24 v8, 911, v1
    v_lshrrev_b32 v8, 14, v8
    v_mad_i32_i24 v1, v8, s15, v1
    v_and_b32 v9, 3, v8
    v_and_b32 v10, 12, v8
    v_lshl_add_u32 v9, v10, 1, v9
    v_bfe_u32 v10, v8, 4, 1
    v_lshl_add_u32 v9, v10, 2, v9
    v_lshlrev_b32 v1, 4, v1
    v_mad_u32_u24 v247, v9, s14, v1
    v_add_u32 v1, 512, v0
    v_mul_u32_u24 v8, 911, v1
    v_lshrrev_b32 v8, 14, v8
    v_mad_i32_i24 v1, v8, s15, v1
    v_and_b32 v9, 3, v8
    v_and_b32 v10, 12, v8
    v_lshl_add_u32 v9, v10, 1, v9
    v_bfe_u32 v10, v8, 4, 1
    v_lshl_add_u32 v9, v10, 2, v9
    v_lshlrev_b32 v1, 4, v1
    v_mad_u32_u24 v248, v9, s14, v1
    s_mul_i32 s9, s3, 18432
    s_mul_i32 s11, s6, 82944
    s_mul_i32 s14, s8, 288
    s_add_u32 s11, s11, s14
    s_mov_b32 s68, s26
    s_mov_b32 s69, s27
    s_mov_b32 s70, 5308416
    s_mov_b32 s71, 0x20000
    s_mov_b32 s72, s28
    s_mov_b32 s73, s29
    s_mov_b32 s74, 5308416
    s_mov_b32 s75, 0x20000
    s_and_b32 s14, s7, 31
    v_cmp_lt_u32 vcc, 8, v0
    s_lshl1_add_u32 s15, s14, 0x200
    v_mov_b32 v4, s15
    v_addc_co_u32 v4, vcc, 0, v4, vcc
    v_subrev_u32 v5, s15, v4
    v_mad_i32_i24 v5, v5, -9, v0
    v_subrev_u32 v6, 18, v0
    v_and_b32 v7, 7, v6
    s_lshl_b32 s15, s14, 3
    s_and_b32 s12, s15, 0xc0
    s_add_u32 s15, s15, s12
    v_add_u32 v7, s15, v7
    v_and_b32 v6, 8, v6
    v_xor_b32 v10, 8, v6
    v_lshl_add_u32 v7, v10, 3, v7
    v_cmp_gt_u32 vcc, 18, v0
    s_mul_i32 s15, s4, 1152
    s_movk_i32 s12, 9216
    v_cndmask_b32 v4, v7, v4, vcc
    v_cndmask_b32 v5, v6, v5, vcc
    v_lshlrev_b32 v5, 7, v5
    v_mad_u32_u24 v4, v4, s12, v5
    s_mov_b32 exec_hi, 3
    s_mov_b32 exec_lo, 0xfffc0000
    buffer_load_dword v200, v4, s[68:71], s15 offen
    buffer_load_dword v201, v4, s[72:75], s15 offen
    s_mov_b64 exec, -1
    v_lshrrev_b32 v4, 2, v0
    v_and_b32 v5, 3, v0
    v_lshl_add_u32 v5, v5, 3, s9
    v_mul_u32_u24 v8, 288, v4
    v_add_u32 v8, v8, v5
    v_and_b32 v4, 3, v4
    v_mul_u32_u24 v9, 288, v4
    s_mul_i32 s13, s8, 2304
    s_add_u32 s13, s13, 150528
    s_sub_u32 s14, s13, s9
    v_add3_u32 v9, v9, v5, s14
    s_mov_b32 s60, s32
    s_mov_b32 s61, s33
    s_mov_b32 s62, 2359296
    s_mov_b32 s63, 0x20000
    v_lshrrev_b32 v4, 2, v0
    v_and_b32 v5, 3, v0
    v_lshlrev_b32 v5, 4, v5
    v_lshl_add_u32 v237, v4, 7, v5
    s_lshl_b32 s14, s3, 11
    s_add_u32 s82, s14, 3473408
    s_mov_b32 s82, 3473408
    v_lshlrev_b32 v237, 4, v0
    s_lshl_b32 s15, s3, 5
    s_add_u32 s15, s15, 147968
    v_lshl_add_u32 v238, v3, 3, s15
    v_lshlrev_b32 v239, 4, v2
    v_add_u32 v239, 147968, v239
    s_lshl_b32 s15, s3, 8
    v_lshl_add_u32 v228, v3, 4, s15
    s_mul_i32 s15, s3, 18432
    v_lshl_add_u32 v229, v0, 3, s15
    s_mul_i32 s14, s3, 192
    s_sub_u32 s14, 1024, s14
    s_cmp_lt_u32 s3, 2
    s_cselect_b32 s14, s14, 0
    s_add_u32 s90, s14, 3932160
    s_and_b32 s14, s6, 1
    s_lshl_b32 s14, s14, 7
    s_add_u32 s88, s14, 3932160
    s_sub_u32 s89, 3932160, s14
    s_mov_b32 s92, 0xaaaaaaaa
    s_mov_b32 s93, 0xaaaaaaaa
    s_mov_b32 s94, 0x00030003
    s_mov_b32 s95, 0x00030003
    s_movk_i32 s91, 144
    s_lshl_b32 s15, s3, 6
    v_add_u32 v4, s15, v0
    v_cmp_gt_u32 vcc, 128, v4
    v_lshrrev_b32 v5, 5, v4
    v_and_b32 v6, 31, v4
    v_lshlrev_b32 v6, 2, v6
    v_lshl_add_u32 v5, v5, 9, v6
    v_add_u32 v6, 2048, v5
    v_add_u32 v7, 2112, v5
    v_cndmask_b32 v230, v6, v5, vcc
    v_cndmask_b32 v231, v7, v6, vcc
    v_and_b32 v5, 1, v4
    v_mul_u32_u24 v5, 191, v5
    v_add_u32 v5, v5, v4
    v_add_u32 v232, 147456, v5
    v_and_b32 v5, 1, v0
    v_mul_u32_u24 v5, 192, v5
    v_lshl_add_u32 v5, v3, 4, v5
    v_add_u32 v233, 147456, v5
    v_lshlrev_b32 v4, 3, v0
    v_lshl_add_u32 v234, v3, 28, v4
    v_lshrrev_b32 v4, 3, v0
    v_mul_u32_u24 v4, 4608, v4
    v_and_b32 v5, 7, v0
    v_lshl_add_u32 v235, v5, 4, v4
    s_lshl_b32 s15, s6, 5
    v_lshl_add_u32 v236, v5, 2, s15
    s_waitcnt vmcnt(0)
    s_barrier
    s_barrier
    s_add_u32 m0, s9, 0
    s_nop 0
    buffer_load_dwordx4 v240, s[76:79], s11 offen lds
    s_add_u32 m0, s9, 1024
    s_nop 0
    buffer_load_dwordx4 v241, s[76:79], s11 offen lds
    s_add_u32 m0, s9, 2048
    s_nop 0
    buffer_load_dwordx4 v242, s[76:79], s11 offen lds
    s_add_u32 m0, s9, 3072
    s_nop 0
    buffer_load_dwordx4 v243, s[76:79], s11 offen lds
    s_add_u32 m0, s9, 4096
    s_nop 0
    buffer_load_dwordx4 v244, s[76:79], s11 offen lds
    s_add_u32 m0, s9, 5120
    s_nop 0
    buffer_load_dwordx4 v245, s[76:79], s11 offen lds
    s_add_u32 m0, s9, 6144
    s_nop 0
    buffer_load_dwordx4 v246, s[76:79], s11 offen lds
    s_add_u32 m0, s9, 7168
    s_nop 0
    buffer_load_dwordx4 v247, s[76:79], s11 offen lds
    s_add_u32 m0, s9, 8192
    s_nop 0
    buffer_load_dwordx4 v248, s[76:79], s11 offen lds
    s_add_u32 s11, s11, 36864
    s_add_u32 m0, s9, 9216
    s_nop 0
    buffer_load_dwordx4 v240, s[76:79], s11 offen lds
    s_add_u32 m0, s9, 10240
    s_nop 0
    buffer_load_dwordx4 v241, s[76:79], s11 offen lds
    s_add_u32 m0, s9, 11264
    s_nop 0
    buffer_load_dwordx4 v242, s[76:79], s11 offen lds
    s_add_u32 m0, s9, 12288
    s_nop 0
    buffer_load_dwordx4 v243, s[76:79], s11 offen lds
    s_add_u32 m0, s9, 13312
    s_nop 0
    buffer_load_dwordx4 v244, s[76:79], s11 offen lds
    s_add_u32 m0, s9, 14336
    s_nop 0
    buffer_load_dwordx4 v245, s[76:79], s11 offen lds
    s_add_u32 m0, s9, 15360
    s_nop 0
    buffer_load_dwordx4 v246, s[76:79], s11 offen lds
    s_add_u32 m0, s9, 16384
    s_nop 0
    buffer_load_dwordx4 v247, s[76:79], s11 offen lds
    s_add_u32 m0, s9, 17408
    s_nop 0
    buffer_load_dwordx4 v248, s[76:79], s11 offen lds
    s_add_u32 s11, s11, 36864
    s_add_u32 m0, s13, 0
    s_mov_b32 exec_lo, -1
    s_mov_b32 exec_hi, -1
    buffer_load_dwordx4 v240, s[76:79], s11 offen lds
    s_add_u32 m0, s13, 1024
    s_mov_b32 exec_lo, 255
    s_mov_b32 exec_hi, 0
    buffer_load_dwordx4 v241, s[76:79], s11 offen lds
    s_add_u32 m0, s13, 640
    s_mov_b32 exec_lo, 0
    s_mov_b32 exec_hi, -1
    buffer_load_dwordx4 v244, s[76:79], s11 offen lds
    s_add_u32 m0, s13, 1664
    s_mov_b32 exec_lo, -1
    s_mov_b32 exec_hi, 255
    buffer_load_dwordx4 v245, s[76:79], s11 offen lds
    s_mov_b64 exec, -1
    s_waitcnt vmcnt(13)
    ds_read_b64_tr_b16 v[16:17], v8 offset:0
    ds_read_b64_tr_b16 v[18:19], v8 offset:4608
    ds_read_b64_tr_b16 v[20:21], v8 offset:32
    ds_read_b64_tr_b16 v[22:23], v8 offset:4640
    ds_read_b64_tr_b16 v[24:25], v8 offset:64
    ds_read_b64_tr_b16 v[26:27], v8 offset:4672
    s_waitcnt lgkmcnt(8)
    ds_read_b64_tr_b16 v[28:29], v8 offset:96
    ds_read_b64_tr_b16 v[30:31], v8 offset:4704
    ds_read_b64_tr_b16 v[32:33], v8 offset:128
    ds_read_b64_tr_b16 v[34:35], v8 offset:4736
    ds_read_b64_tr_b16 v[36:37], v8 offset:160
    ds_read_b64_tr_b16 v[38:39], v8 offset:4768
    s_waitcnt lgkmcnt(8)
    ds_read_b64_tr_b16 v[40:41], v8 offset:192
    ds_read_b64_tr_b16 v[42:43], v8 offset:4800
    ds_read_b64_tr_b16 v[44:45], v8 offset:224
    ds_read_b64_tr_b16 v[46:47], v8 offset:4832
    ds_read_b64_tr_b16 v[48:49], v8 offset:256
    ds_read_b64_tr_b16 v[50:51], v8 offset:4864
    s_waitcnt lgkmcnt(8)
    s_waitcnt vmcnt(4)
    ds_read_b64_tr_b16 v[52:53], v8 offset:9216
    ds_read_b64_tr_b16 v[54:55], v8 offset:13824
    ds_read_b64_tr_b16 v[56:57], v8 offset:9248
    ds_read_b64_tr_b16 v[58:59], v8 offset:13856
    ds_read_b64_tr_b16 v[60:61], v8 offset:9280
    ds_read_b64_tr_b16 v[62:63], v8 offset:13888
    s_waitcnt lgkmcnt(8)
    ds_read_b64_tr_b16 v[64:65], v8 offset:9312
    ds_read_b64_tr_b16 v[66:67], v8 offset:13920
    ds_read_b64_tr_b16 v[68:69], v8 offset:9344
    ds_read_b64_tr_b16 v[70:71], v8 offset:13952
    ds_read_b64_tr_b16 v[72:73], v8 offset:9376
    ds_read_b64_tr_b16 v[74:75], v8 offset:13984
    s_waitcnt lgkmcnt(8)
    ds_read_b64_tr_b16 v[76:77], v8 offset:9408
    ds_read_b64_tr_b16 v[78:79], v8 offset:14016
    ds_read_b64_tr_b16 v[80:81], v8 offset:9440
    ds_read_b64_tr_b16 v[82:83], v8 offset:14048
    ds_read_b64_tr_b16 v[84:85], v8 offset:9472
    ds_read_b64_tr_b16 v[86:87], v8 offset:14080
    s_waitcnt lgkmcnt(8)
    s_waitcnt vmcnt(0)
    ds_read_b64_tr_b16 v[88:89], v9 offset:0
    ds_read_b64_tr_b16 v[90:91], v9 offset:1152
    ds_read_b64_tr_b16 v[92:93], v9 offset:32
    ds_read_b64_tr_b16 v[94:95], v9 offset:1184
    ds_read_b64_tr_b16 v[96:97], v9 offset:64
    ds_read_b64_tr_b16 v[98:99], v9 offset:1216
    s_waitcnt lgkmcnt(8)
    ds_read_b64_tr_b16 v[100:101], v9 offset:96
    ds_read_b64_tr_b16 v[102:103], v9 offset:1248
    ds_read_b64_tr_b16 v[104:105], v9 offset:128
    ds_read_b64_tr_b16 v[106:107], v9 offset:1280
    ds_read_b64_tr_b16 v[108:109], v9 offset:160
    ds_read_b64_tr_b16 v[110:111], v9 offset:1312
    s_waitcnt lgkmcnt(8)
    ds_read_b64_tr_b16 v[112:113], v9 offset:192
    ds_read_b64_tr_b16 v[114:115], v9 offset:1344
    ds_read_b64_tr_b16 v[116:117], v9 offset:224
    ds_read_b64_tr_b16 v[118:119], v9 offset:1376
    ds_read_b64_tr_b16 v[120:121], v9 offset:256
    ds_read_b64_tr_b16 v[122:123], v9 offset:1408
    s_waitcnt lgkmcnt(8)
    s_branch L_H_keys
    .fill 694, 4, 0xbf810000
L_H_lo:
    v_mov_b32 v12, 0
    v_mov_b32 v13, 0
    v_mov_b32 v14, 0
    v_mov_b32 v15, 0
    s_lshl_b32 s14, s7, 10
    s_add_u32 s14, s14, 2359296
    s_mul_i32 s15, s6, 3
    s_add_u32 s15, s15, s8
    s_lshl_b32 s15, s15, 9
    s_add_u32 s15, s15, 3407360
    s_min_u32 s15, s15, 3497472
    s_cmp_eq_u32 s8, 0
    s_cselect_b32 s15, 3497984, s15
    s_cselect_b32 s12, s83, 0
    s_cselect_b32 s13, s84, 0
    v_mov_b32 v4, s12
    v_mov_b32 v5, s13
    v_cmp_gt_u32 vcc, 16, v0
    s_waitcnt lgkmcnt(0)
    s_mov_b32 s48, s36
    s_mov_b32 s49, s37
    s_mov_b32 s50, 4526080
    s_mov_b32 s51, 0x20000
    v_cndmask_b32 v4, v5, v4, vcc
    v_lshl_add_u32 v4, v4, 9, v11
    s_cmp_ge_u32 s8, 2
    s_cbranch_scc1 L_H_noep
    s_lshl_b32 s12, s8, 2
    s_lshr_b32 s12, 0x3578, s12
    s_and_b32 s12, s12, 15
    s_and_b32 s13, s4, 3
    s_lshl1_add_u32 s12, s13, s12
    s_lshr_b32 s13, s4, 2
    s_add_u32 s12, s12, s13
    v_bfe_u32 v5, v0, 3, 1
    v_add_u32 v6, s12, v5
    v_subrev_u32 v7, 9, v6
    v_min_u32 v6, v6, v7
    v_and_b32 v7, 7, v0
    v_lshl_add_u32 v6, v6, 6, v7
    s_and_b32 s12, s6, 7
    s_lshl_b32 s12, s12, 3
    v_add_u32 v6, s12, v6
    v_mul_u32_u24 v6, 3456, v6
    v_add_u32 v5, s13, v5
    v_lshl_add_u32 v6, v5, 9, v6
    v_mul_u32_u24 v5, 1152, v3
    v_add_u32 v6, v6, v5
    s_mov_b32 exec_hi, 0
    global_load_dword v20, v6, s[18:19] offset:1152
L_H_noep:
    s_mov_b64 exec, -1
    v_mov_b32 v30, v4
    s_mov_b32 s87, s15
    s_mov_b32 s86, s14
    s_mov_b32 exec_hi, 0
    buffer_store_dwordx4 v[12:15], v30, s[48:51], s87 offen sc1
    s_mov_b64 exec, -1
    buffer_store_dwordx4 v[12:15], v11, s[48:51], s86 offen sc1
    s_add_u32 s86, s86, 262144
    buffer_store_dwordx4 v[12:15], v11, s[48:51], s86 offen sc1
    s_add_u32 s86, s86, 262144
    buffer_store_dwordx4 v[12:15], v11, s[48:51], s86 offen sc1
    s_add_u32 s86, s86, 262144
    buffer_store_dwordx4 v[12:15], v11, s[48:51], s86 offen sc1
    s_mov_b32 s52, s34
    s_mov_b32 s53, s35
    s_mov_b32 s54, 256
    s_mov_b32 s55, 0x20000
    v_lshlrev_b32 v6, 3, v0
    v_add_u32 v6, 147456, v6
    ds_write_b64 v6, v[12:13]
    v_mov_b32 v252, 163200
    v_mov_b32 v253, 1
    ds_write_b128 v252, v[12:15]
    ds_write_b128 v252, v[12:15] offset:16
    s_movk_i32 s14, 9216
    v_add_u32 v1, 0, v0
    v_mul_u32_u24 v8, 911, v1
    v_lshrrev_b32 v8, 13, v8
    v_mad_i32_i24 v1, v8, -9, v1
    v_and_b32 v9, 35, v8
    v_and_b32 v10, 12, v8
    v_lshl_add_u32 v9, v10, 1, v9
    v_bfe_u32 v10, v8, 4, 1
    v_lshl_add_u32 v9, v10, 2, v9
    v_lshlrev_b32 v1, 4, v1
    v_mad_u32_u24 v240, v9, s14, v1
    v_add_u32 v1, 64, v0
    v_mul_u32_u24 v8, 911, v1
    v_lshrrev_b32 v8, 13, v8
    v_mad_i32_i24 v1, v8, -9, v1
    v_and_b32 v9, 35, v8
    v_and_b32 v10, 12, v8
    v_lshl_add_u32 v9, v10, 1, v9
    v_bfe_u32 v10, v8, 4, 1
    v_lshl_add_u32 v9, v10, 2, v9
    v_lshlrev_b32 v1, 4, v1
    v_mad_u32_u24 v241, v9, s14, v1
    v_add_u32 v1, 128, v0
    v_mul_u32_u24 v8, 911, v1
    v_lshrrev_b32 v8, 13, v8
    v_mad_i32_i24 v1, v8, -9, v1
    v_and_b32 v9, 35, v8
    v_and_b32 v10, 12, v8
    v_lshl_add_u32 v9, v10, 1, v9
    v_bfe_u32 v10, v8, 4, 1
    v_lshl_add_u32 v9, v10, 2, v9
    v_lshlrev_b32 v1, 4, v1
    v_mad_u32_u24 v242, v9, s14, v1
    v_add_u32 v1, 192, v0
    v_mul_u32_u24 v8, 911, v1
    v_lshrrev_b32 v8, 13, v8
    v_mad_i32_i24 v1, v8, -9, v1
    v_and_b32 v9, 35, v8
    v_and_b32 v10, 12, v8
    v_lshl_add_u32 v9, v10, 1, v9
    v_bfe_u32 v10, v8, 4, 1
    v_lshl_add_u32 v9, v10, 2, v9
    v_lshlrev_b32 v1, 4, v1
    v_mad_u32_u24 v243, v9, s14, v1
    v_add_u32 v1, 256, v0
    v_mul_u32_u24 v8, 911, v1
    v_lshrrev_b32 v8, 13, v8
    v_mad_i32_i24 v1, v8, -9, v1
    v_and_b32 v9, 35, v8
    v_and_b32 v10, 12, v8
    v_lshl_add_u32 v9, v10, 1, v9
    v_bfe_u32 v10, v8, 4, 1
    v_lshl_add_u32 v9, v10, 2, v9
    v_lshlrev_b32 v1, 4, v1
    v_mad_u32_u24 v244, v9, s14, v1
    v_add_u32 v1, 320, v0
    v_mul_u32_u24 v8, 911, v1
    v_lshrrev_b32 v8, 13, v8
    v_mad_i32_i24 v1, v8, -9, v1
    v_and_b32 v9, 35, v8
    v_and_b32 v10, 12, v8
    v_lshl_add_u32 v9, v10, 1, v9
    v_bfe_u32 v10, v8, 4, 1
    v_lshl_add_u32 v9, v10, 2, v9
    v_lshlrev_b32 v1, 4, v1
    v_mad_u32_u24 v245, v9, s14, v1
    v_add_u32 v1, 384, v0
    v_mul_u32_u24 v8, 911, v1
    v_lshrrev_b32 v8, 13, v8
    v_mad_i32_i24 v1, v8, -9, v1
    v_and_b32 v9, 35, v8
    v_and_b32 v10, 12, v8
    v_lshl_add_u32 v9, v10, 1, v9
    v_bfe_u32 v10, v8, 4, 1
    v_lshl_add_u32 v9, v10, 2, v9
    v_lshlrev_b32 v1, 4, v1
    v_mad_u32_u24 v246, v9, s14, v1
    v_add_u32 v1, 448, v0
    v_mul_u32_u24 v8, 911, v1
    v_lshrrev_b32 v8, 13, v8
    v_mad_i32_i24 v1, v8, -9, v1
    v_and_b32 v9, 35, v8
    v_and_b32 v10, 12, v8
    v_lshl_add_u32 v9, v10, 1, v9
    v_bfe_u32 v10, v8, 4, 1
    v_lshl_add_u32 v9, v10, 2, v9
    v_lshlrev_b32 v1, 4, v1
    v_mad_u32_u24 v247, v9, s14, v1
    v_add_u32 v1, 512, v0
    v_mul_u32_u24 v8, 911, v1
    v_lshrrev_b32 v8, 13, v8
    v_mad_i32_i24 v1, v8, -9, v1
    v_and_b32 v9, 35, v8
    v_and_b32 v10, 12, v8
    v_lshl_add_u32 v9, v10, 1, v9
    v_bfe_u32 v10, v8, 4, 1
    v_lshl_add_u32 v9, v10, 2, v9
    v_lshlrev_b32 v1, 4, v1
    v_mad_u32_u24 v248, v9, s14, v1
    s_mov_b32 s68, s26
    s_mov_b32 s69, s27
    s_mov_b32 s70, 5308416
    s_mov_b32 s71, 0x20000
    s_mov_b32 s72, s28
    s_mov_b32 s73, s29
    s_mov_b32 s74, 5308416
    s_mov_b32 s75, 0x20000
    s_mul_i32 s9, s3, 18432
    s_mul_i32 s10, s6, 144
    s_mul_i32 s14, s3, 1179648
    s_add_u32 s11, s10, s14
    s_add_u32 s12, s11, 589824
    s_bitcmp1_b32 s6, 0
    s_cselect_b32 s14, s12, s11
    s_cselect_b32 s12, s11, s12
    s_mov_b32 s11, s14
    v_lshrrev_b32 v4, 2, v0
    v_mul_u32_u24 v4, 144, v4
    v_add_u32 v4, s9, v4
    v_and_b32 v5, 3, v0
    v_lshl_add_u32 v8, v5, 3, v4
    v_and_b32 v5, 1, v0
    v_lshl_add_u32 v4, v5, 3, v4
    v_bfe_u32 v5, v0, 1, 1
    v_mul_u32_u24 v6, 9216, v5
    v_add_u32 v9, v6, v4
    v_mul_u32_u24 v6, 36864, v5
    v_add_u32 v10, v6, v4
    s_waitcnt lgkmcnt(0)
    s_barrier
    s_waitcnt vmcnt(0)
    s_mov_b64 exec, 1
    ds_add_u32 v252, v253 offset:0
    s_mov_b64 exec, -1
    s_mov_b32 s38, 1600000
L_cw_25:
    ds_read_b32 v1, v252 offset:0
    s_waitcnt lgkmcnt(0)
    v_readfirstlane_b32 s14, v1
    s_nop 0
    s_cmp_ge_u32 s14, 4
    s_cbranch_scc1 L_cok_26
    s_sub_u32 s38, s38, 1
    s_cbranch_scc0 L_cw_25
L_cok_26:
    s_cmp_lg_u32 s3, 0
    s_cbranch_scc1 L_H_nogo2
    v_mov_b32 v4, 0
    s_mov_b64 exec, 1
    buffer_atomic_add v253, v4, s[52:55], 0 offen sc1
    s_mov_b64 exec, -1
L_H_nogo2:
    s_sleep 2
    s_mov_b32 s56, s20
    s_mov_b32 s57, s21
    s_mov_b32 s58, 663552
    s_mov_b32 s59, 0x20000
    v_lshlrev_b32 v6, 7, v0
    s_add_u32 s14, s6, s4
    s_add_u32 s14, s14, 4
    s_and_b32 s14, s14, 7
    s_cmp_ge_u32 s14, 6
    s_cbranch_scc1 L_H_nowo
    s_lshl2_add_u32 s14, s14, s8
    s_mul_i32 s14, s14, 27648
    s_mov_b32 exec_hi, 0x3fffff
    buffer_load_dword v16, v6, s[56:59], s14 offen
    s_add_u32 s14, s14, 6912
    buffer_load_dword v17, v6, s[56:59], s14 offen
    s_add_u32 s14, s14, 6912
    buffer_load_dword v18, v6, s[56:59], s14 offen
    s_add_u32 s14, s14, 6912
    buffer_load_dword v19, v6, s[56:59], s14 offen
    s_mov_b64 exec, -1
L_H_nowo:
    s_add_u32 m0, s9, 0
    s_nop 0
    buffer_load_dwordx4 v240, s[68:71], s11 offen lds
    s_waitcnt vmcnt(4)
    s_add_u32 m0, s9, 1024
    s_nop 0
    buffer_load_dwordx4 v241, s[68:71], s11 offen lds
    s_waitcnt vmcnt(4)
    s_add_u32 m0, s9, 2048
    s_nop 0
    buffer_load_dwordx4 v242, s[68:71], s11 offen lds
    s_waitcnt vmcnt(4)
    s_add_u32 m0, s9, 3072
    s_nop 0
    buffer_load_dwordx4 v243, s[68:71], s11 offen lds
    s_waitcnt vmcnt(4)
    s_add_u32 m0, s9, 4096
    s_nop 0
    buffer_load_dwordx4 v244, s[68:71], s11 offen lds
    s_waitcnt vmcnt(4)
    s_add_u32 m0, s9, 5120
    s_nop 0
    buffer_load_dwordx4 v245, s[68:71], s11 offen lds
    s_waitcnt vmcnt(4)
    s_add_u32 m0, s9, 6144
    s_nop 0
    buffer_load_dwordx4 v246, s[68:71], s11 offen lds
    s_waitcnt vmcnt(4)
    s_add_u32 m0, s9, 7168
    s_nop 0
    buffer_load_dwordx4 v247, s[68:71], s11 offen lds
    s_waitcnt vmcnt(4)
    s_add_u32 m0, s9, 8192
    s_nop 0
    buffer_load_dwordx4 v248, s[68:71], s11 offen lds
    s_waitcnt vmcnt(4)
    s_add_u32 m0, s9, 9216
    s_nop 0
    buffer_load_dwordx4 v240, s[72:75], s11 offen lds
    s_add_u32 m0, s9, 10240
    s_nop 0
    buffer_load_dwordx4 v241, s[72:75], s11 offen lds
    s_add_u32 m0, s9, 11264
    s_nop 0
    buffer_load_dwordx4 v242, s[72:75], s11 offen lds
    s_add_u32 m0, s9, 12288
    s_nop 0
    buffer_load_dwordx4 v243, s[72:75], s11 offen lds
    s_add_u32 m0, s9, 13312
    s_nop 0
    buffer_load_dwordx4 v244, s[72:75], s11 offen lds
    s_add_u32 m0, s9, 14336
    s_nop 0
    buffer_load_dwordx4 v245, s[72:75], s11 offen lds
    s_add_u32 m0, s9, 15360
    s_nop 0
    buffer_load_dwordx4 v246, s[72:75], s11 offen lds
    s_add_u32 m0, s9, 16384
    s_nop 0
    buffer_load_dwordx4 v247, s[72:75], s11 offen lds
    s_add_u32 m0, s9, 17408
    s_nop 0
    buffer_load_dwordx4 v248, s[72:75], s11 offen lds
    s_cmp_ge_u32 s3, 2
    s_cbranch_scc1 L_H_no5
    s_add_u32 s14, s3, 16
    s_mul_i32 s11, s14, 294912
    s_add_u32 s11, s11, s10
    s_add_u32 m0, s9, 82944
    s_nop 0
    buffer_load_dwordx4 v240, s[68:71], s11 offen lds
    s_add_u32 m0, s9, 83968
    s_nop 0
    buffer_load_dwordx4 v241, s[68:71], s11 offen lds
    s_add_u32 m0, s9, 84992
    s_nop 0
    buffer_load_dwordx4 v242, s[68:71], s11 offen lds
    s_add_u32 m0, s9, 86016
    s_nop 0
    buffer_load_dwordx4 v243, s[68:71], s11 offen lds
    s_add_u32 m0, s9, 87040
    s_mov_b32 exec_hi, 0
    buffer_load_dwordx4 v244, s[68:71], s11 offen lds
    s_mov_b32 exec_hi, -1
    s_add_u32 m0, s9, 119808
    s_nop 0
    buffer_load_dwordx4 v240, s[72:75], s11 offen lds
    s_add_u32 m0, s9, 120832
    s_nop 0
    buffer_load_dwordx4 v241, s[72:75], s11 offen lds
    s_add_u32 m0, s9, 121856
    s_nop 0
    buffer_load_dwordx4 v242, s[72:75], s11 offen lds
    s_add_u32 m0, s9, 122880
    s_nop 0
    buffer_load_dwordx4 v243, s[72:75], s11 offen lds
    s_add_u32 m0, s9, 123904
    s_mov_b32 exec_hi, 0
    buffer_load_dwordx4 v244, s[72:75], s11 offen lds
    s_mov_b32 exec_hi, -1
L_H_no5:
    s_mov_b32 s60, s32
    s_mov_b32 s61, s33
    s_mov_b32 s62, 2359296
    s_mov_b32 s63, 0x20000
    v_lshrrev_b32 v4, 2, v0
    v_and_b32 v5, 3, v0
    v_lshlrev_b32 v5, 4, v5
    v_lshl_add_u32 v237, v4, 7, v5
    s_lshl_b32 s14, s3, 11
    s_add_u32 s82, s14, 3473408
    s_mov_b32 s82, 3473408
    v_lshlrev_b32 v237, 4, v0
    s_lshl_b32 s15, s3, 5
    s_add_u32 s15, s15, 147968
    v_lshl_add_u32 v238, v3, 3, s15
    v_lshlrev_b32 v239, 4, v2
    v_add_u32 v239, 147968, v239
    s_lshl_b32 s15, s3, 8
    v_lshl_add_u32 v228, v3, 4, s15
    s_mul_i32 s15, s3, 18432
    v_lshl_add_u32 v229, v0, 3, s15
    s_mul_i32 s14, s3, 192
    s_sub_u32 s14, 1024, s14
    s_cmp_lt_u32 s3, 2
    s_cselect_b32 s14, s14, 0
    s_add_u32 s90, s14, 3932160
    s_and_b32 s14, s6, 1
    s_lshl_b32 s14, s14, 7
    s_add_u32 s88, s14, 3932160
    s_sub_u32 s89, 3932160, s14
    s_mov_b32 s92, 0xaaaaaaaa
    s_mov_b32 s93, 0xaaaaaaaa
    s_mov_b32 s94, 0x00030003
    s_mov_b32 s95, 0x00030003
    s_movk_i32 s91, 144
    s_lshl_b32 s15, s3, 6
    v_add_u32 v4, s15, v0
    v_cmp_gt_u32 vcc, 128, v4
    v_lshrrev_b32 v5, 5, v4
    v_and_b32 v6, 31, v4
    v_lshlrev_b32 v6, 2, v6
    v_lshl_add_u32 v5, v5, 9, v6
    v_add_u32 v6, 2048, v5
    v_add_u32 v7, 2112, v5
    v_cndmask_b32 v230, v6, v5, vcc
    v_cndmask_b32 v231, v7, v6, vcc
    v_and_b32 v5, 1, v4
    v_mul_u32_u24 v5, 191, v5
    v_add_u32 v5, v5, v4
    v_add_u32 v232, 147456, v5
    v_and_b32 v5, 1, v0
    v_mul_u32_u24 v5, 192, v5
    v_lshl_add_u32 v5, v3, 4, v5
    v_add_u32 v233, 147456, v5
    v_lshlrev_b32 v4, 3, v0
    v_lshl_add_u32 v234, v3, 28, v4
    v_lshrrev_b32 v4, 3, v0
    v_mul_u32_u24 v4, 4608, v4
    v_and_b32 v5, 7, v0
    v_lshl_add_u32 v235, v5, 4, v4
    s_lshl_b32 s15, s6, 5
    v_lshl_add_u32 v236, v5, 2, s15
    s_mov_b32 s38, 400000
    s_mov_b32 s52, s34
    s_mov_b32 s53, s35
    s_mov_b32 s54, 256
    s_mov_b32 s55, 0x20000
    v_mov_b32 v4, 0
L_H_flag:
    buffer_load_dword v5, v4, s[52:55], 0 offen sc1
    s_waitcnt vmcnt(0)
    v_cmp_gt_u32 vcc, 64, v5
    s_cbranch_vccz L_H_flag_ok
    s_sleep 24
    s_sub_u32 s38, s38, 1
    s_cbranch_scc0 L_H_flag
L_H_flag_ok:
    ds_read_b64_tr_b16 v[16:17], v8 offset:0
    ds_read_b64_tr_b16 v[18:19], v8 offset:2304
    ds_read_b64_tr_b16 v[20:21], v8 offset:32
    ds_read_b64_tr_b16 v[22:23], v8 offset:2336
    ds_read_b64_tr_b16 v[24:25], v8 offset:64
    ds_read_b64_tr_b16 v[26:27], v8 offset:2368
    s_waitcnt lgkmcnt(8)
    ds_read_b64_tr_b16 v[28:29], v8 offset:96
    ds_read_b64_tr_b16 v[30:31], v8 offset:2400
    ds_read_b64_tr_b16 v[32:33], v8 offset:9216
    ds_read_b64_tr_b16 v[34:35], v8 offset:11520
    ds_read_b64_tr_b16 v[36:37], v8 offset:9248
    ds_read_b64_tr_b16 v[38:39], v8 offset:11552
    s_waitcnt lgkmcnt(8)
    ds_read_b64_tr_b16 v[40:41], v8 offset:9280
    ds_read_b64_tr_b16 v[42:43], v8 offset:11584
    ds_read_b64_tr_b16 v[44:45], v8 offset:9312
    ds_read_b64_tr_b16 v[46:47], v8 offset:11616
    ds_read_b64_tr_b16 v[48:49], v9 offset:128
    ds_read_b64_tr_b16 v[50:51], v9 offset:2432
    s_waitcnt lgkmcnt(8)
    ds_read_b64_tr_b16 v[52:53], v8 offset:4608
    ds_read_b64_tr_b16 v[54:55], v8 offset:6912
    ds_read_b64_tr_b16 v[56:57], v8 offset:4640
    ds_read_b64_tr_b16 v[58:59], v8 offset:6944
    ds_read_b64_tr_b16 v[60:61], v8 offset:4672
    ds_read_b64_tr_b16 v[62:63], v8 offset:6976
    s_waitcnt lgkmcnt(8)
    ds_read_b64_tr_b16 v[64:65], v8 offset:4704
    ds_read_b64_tr_b16 v[66:67], v8 offset:7008
    ds_read_b64_tr_b16 v[68:69], v8 offset:13824
    ds_read_b64_tr_b16 v[70:71], v8 offset:16128
    ds_read_b64_tr_b16 v[72:73], v8 offset:13856
    ds_read_b64_tr_b16 v[74:75], v8 offset:16160
    s_waitcnt lgkmcnt(8)
    ds_read_b64_tr_b16 v[76:77], v8 offset:13888
    ds_read_b64_tr_b16 v[78:79], v8 offset:16192
    ds_read_b64_tr_b16 v[80:81], v8 offset:13920
    ds_read_b64_tr_b16 v[82:83], v8 offset:16224
    ds_read_b64_tr_b16 v[84:85], v9 offset:4736
    ds_read_b64_tr_b16 v[86:87], v9 offset:7040
    s_waitcnt lgkmcnt(8)
    s_cmp_ge_u32 s3, 2
    s_cbranch_scc1 L_H_no5b
    v_add_u32 v4, 82944, v8
    v_add_u32 v10, 82944, v10
    ds_read_b64_tr_b16 v[160:161], v4 offset:0
    ds_read_b64_tr_b16 v[162:163], v4 offset:2304
    ds_read_b64_tr_b16 v[164:165], v4 offset:32
    ds_read_b64_tr_b16 v[166:167], v4 offset:2336
    ds_read_b64_tr_b16 v[168:169], v4 offset:64
    ds_read_b64_tr_b16 v[170:171], v4 offset:2368
    s_waitcnt lgkmcnt(8)
    ds_read_b64_tr_b16 v[172:173], v4 offset:96
    ds_read_b64_tr_b16 v[174:175], v4 offset:2400
    ds_read_b64_tr_b16 v[176:177], v4 offset:36864
    ds_read_b64_tr_b16 v[178:179], v4 offset:39168
    ds_read_b64_tr_b16 v[180:181], v4 offset:36896
    ds_read_b64_tr_b16 v[182:183], v4 offset:39200
    s_waitcnt lgkmcnt(8)
    ds_read_b64_tr_b16 v[184:185], v4 offset:36928
    ds_read_b64_tr_b16 v[186:187], v4 offset:39232
    ds_read_b64_tr_b16 v[188:189], v4 offset:36960
    ds_read_b64_tr_b16 v[190:191], v4 offset:39264
    ds_read_b64_tr_b16 v[192:193], v10 offset:128
    ds_read_b64_tr_b16 v[194:195], v10 offset:2432
    s_waitcnt lgkmcnt(8)
L_H_no5b:
    s_waitcnt lgkmcnt(0)
    s_barrier
    s_add_u32 m0, s9, 0
    s_nop 0
    buffer_load_dwordx4 v240, s[68:71], s12 offen lds
    s_add_u32 m0, s9, 1024
    s_nop 0
    buffer_load_dwordx4 v241, s[68:71], s12 offen lds
    s_add_u32 m0, s9, 2048
    s_nop 0
    buffer_load_dwordx4 v242, s[68:71], s12 offen lds
    s_add_u32 m0, s9, 3072
    s_nop 0
    buffer_load_dwordx4 v243, s[68:71], s12 offen lds
    s_add_u32 m0, s9, 4096
    s_nop 0
    buffer_load_dwordx4 v244, s[68:71], s12 offen lds
    s_add_u32 m0, s9, 5120
    s_nop 0
    buffer_load_dwordx4 v245, s[68:71], s12 offen lds
    s_add_u32 m0, s9, 6144
    s_nop 0
    buffer_load_dwordx4 v246, s[68:71], s12 offen lds
    s_add_u32 m0, s9, 7168
    s_nop 0
    buffer_load_dwordx4 v247, s[68:71], s12 offen lds
    s_add_u32 m0, s9, 8192
    s_nop 0
    buffer_load_dwordx4 v248, s[68:71], s12 offen lds
    s_add_u32 m0, s9, 9216
    s_nop 0
    buffer_load_dwordx4 v240, s[72:75], s12 offen lds
    s_add_u32 m0, s9, 10240
    s_nop 0
    buffer_load_dwordx4 v241, s[72:75], s12 offen lds
    s_add_u32 m0, s9, 11264
    s_nop 0
    buffer_load_dwordx4 v242, s[72:75], s12 offen lds
    s_add_u32 m0, s9, 12288
    s_nop 0
    buffer_load_dwordx4 v243, s[72:75], s12 offen lds
    s_add_u32 m0, s9, 13312
    s_nop 0
    buffer_load_dwordx4 v244, s[72:75], s12 offen lds
    s_add_u32 m0, s9, 14336
    s_nop 0
    buffer_load_dwordx4 v245, s[72:75], s12 offen lds
    s_add_u32 m0, s9, 15360
    s_nop 0
    buffer_load_dwordx4 v246, s[72:75], s12 offen lds
    s_add_u32 m0, s9, 16384
    s_nop 0
    buffer_load_dwordx4 v247, s[72:75], s12 offen lds
    s_add_u32 m0, s9, 17408
    s_nop 0
    buffer_load_dwordx4 v248, s[72:75], s12 offen lds
    s_barrier
    s_waitcnt vmcnt(0)
    ds_read_b64_tr_b16 v[88:89], v8 offset:0
    ds_read_b64_tr_b16 v[90:91], v8 offset:2304
    ds_read_b64_tr_b16 v[92:93], v8 offset:32
    ds_read_b64_tr_b16 v[94:95], v8 offset:2336
    ds_read_b64_tr_b16 v[96:97], v8 offset:64
    ds_read_b64_tr_b16 v[98:99], v8 offset:2368
    s_waitcnt lgkmcnt(8)
    ds_read_b64_tr_b16 v[100:101], v8 offset:96
    ds_read_b64_tr_b16 v[102:103], v8 offset:2400
    ds_read_b64_tr_b16 v[104:105], v8 offset:9216
    ds_read_b64_tr_b16 v[106:107], v8 offset:11520
    ds_read_b64_tr_b16 v[108:109], v8 offset:9248
    ds_read_b64_tr_b16 v[110:111], v8 offset:11552
    s_waitcnt lgkmcnt(8)
    ds_read_b64_tr_b16 v[112:113], v8 offset:9280
    ds_read_b64_tr_b16 v[114:115], v8 offset:11584
    ds_read_b64_tr_b16 v[116:117], v8 offset:9312
    ds_read_b64_tr_b16 v[118:119], v8 offset:11616
    ds_read_b64_tr_b16 v[120:121], v9 offset:128
    ds_read_b64_tr_b16 v[122:123], v9 offset:2432
    s_waitcnt lgkmcnt(8)
    ds_read_b64_tr_b16 v[124:125], v8 offset:4608
    ds_read_b64_tr_b16 v[126:127], v8 offset:6912
    ds_read_b64_tr_b16 v[128:129], v8 offset:4640
    ds_read_b64_tr_b16 v[130:131], v8 offset:6944
    ds_read_b64_tr_b16 v[132:133], v8 offset:4672
    ds_read_b64_tr_b16 v[134:135], v8 offset:6976
    s_waitcnt lgkmcnt(8)
    ds_read_b64_tr_b16 v[136:137], v8 offset:4704
    ds_read_b64_tr_b16 v[138:139], v8 offset:7008
    ds_read_b64_tr_b16 v[140:141], v8 offset:13824
    ds_read_b64_tr_b16 v[142:143], v8 offset:16128
    ds_read_b64_tr_b16 v[144:145], v8 offset:13856
    ds_read_b64_tr_b16 v[146:147], v8 offset:16160
    s_waitcnt lgkmcnt(8)
    ds_read_b64_tr_b16 v[148:149], v8 offset:13888
    ds_read_b64_tr_b16 v[150:151], v8 offset:16192
    ds_read_b64_tr_b16 v[152:153], v8 offset:13920
    ds_read_b64_tr_b16 v[154:155], v8 offset:16224
    ds_read_b64_tr_b16 v[156:157], v9 offset:4736
    ds_read_b64_tr_b16 v[158:159], v9 offset:7040
    s_waitcnt lgkmcnt(8)
L_H_keys:
    s_waitcnt lgkmcnt(0)
    s_cmp_ge_u32 s3, 4
    s_cbranch_scc1 L_H_down
    s_lshl_b32 s14, s4, 10
    s_add_u32 s14, s14, 3489856
    v_lshlrev_b32 v5, 2, v0
    s_mov_b32 s38, 60
    s_mov_b64 exec, 0xffff
L_H_kh:
    buffer_load_dword v4, v5, s[48:51], s14 offen sc1
    s_waitcnt vmcnt(0)
    v_cmp_eq_u32 vcc, 0, v4
    s_cbranch_vccz L_H_khok
    s_sleep 1
    s_sub_u32 s38, s38, 1
    s_cbranch_scc0 L_H_kh
L_H_khok:
    s_mov_b64 exec, -1
    s_sleep 3
    s_mov_b32 s38, 400000
L_H_kpoll:
    buffer_load_dwordx4 v[200:203], v237, s[48:51], s82 offen sc1
    s_waitcnt vmcnt(0)
    v_min3_u32 v4, v200, v201, v202
    v_min_u32 v4, v4, v203
    v_cmp_eq_u32 vcc, 0, v4
    s_nop 0
    s_and_b64 exec, exec, vcc
    s_cbranch_scc0 L_H_kok
    s_sub_u32 s38, s38, 1
    s_cbranch_scc0 L_H_kpoll
L_H_kok:
    s_mov_b64 exec, -1
    v_max_u32 v204, v200, v202
    v_max_u32 v205, v201, v203
    v_med3_u32 v205, v200, v205, v202
    v_min_u32_dpp v206, v204, v204 row_ror:8 row_mask:0xf bank_mask:0xf
    v_max_u32_dpp v204, v204, v204 row_ror:8 row_mask:0xf bank_mask:0xf
    v_max_u32_dpp v207, v205, v205 row_ror:8 row_mask:0xf bank_mask:0xf
    v_max_u32 v205, v206, v207
    v_min_u32_dpp v206, v204, v204 row_ror:4 row_mask:0xf bank_mask:0xf
    v_max_u32_dpp v204, v204, v204 row_ror:4 row_mask:0xf bank_mask:0xf
    v_max_u32_dpp v207, v205, v205 row_ror:4 row_mask:0xf bank_mask:0xf
    v_max_u32 v205, v206, v207
    v_min_u32_dpp v206, v204, v204 row_ror:2 row_mask:0xf bank_mask:0xf
    v_max_u32_dpp v204, v204, v204 row_ror:2 row_mask:0xf bank_mask:0xf
    v_max_u32_dpp v207, v205, v205 row_ror:2 row_mask:0xf bank_mask:0xf
    v_max_u32 v205, v206, v207
    v_min_u32_dpp v206, v204, v204 row_ror:1 row_mask:0xf bank_mask:0xf
    v_max_u32_dpp v204, v204, v204 row_ror:1 row_mask:0xf bank_mask:0xf
    v_max_u32_dpp v207, v205, v205 row_ror:1 row_mask:0xf bank_mask:0xf
    v_max_u32 v205, v206, v207
    v_mov_b32 v206, v204
    v_mov_b32 v207, v205
    s_nop 0
    v_permlane16_swap_b32 v204, v206
    v_permlane16_swap_b32 v205, v207
    v_max_u32 v205, v205, v207
    v_med3_u32 v205, v204, v205, v206
    v_max_u32 v204, v204, v206
    v_mov_b32 v206, v204
    v_mov_b32 v207, v205
    s_nop 0
    v_permlane32_swap_b32 v204, v206
    v_permlane32_swap_b32 v205, v207
    v_max_u32 v205, v205, v207
    v_med3_u32 v205, v204, v205, v206
    v_max_u32 v204, v204, v206
    v_cndmask_b32 v4, v204, v205, s[92:93]
    v_xor_b32 v5, v204, v205
    v_not_b32 v4, v4
    v_and_b32 v5, 0x7f0, v5
    v_and_b32 v4, 0x7f0, v4
    v_cmp_eq_u32 vcc, 0, v5
    v_mad_u32_u24 v1, v4, s91, v228
    s_and_b64 vcc, vcc, s[92:93]
    v_add_u32 v5, 1152, v1
    v_cndmask_b32 v1, v1, v5, vcc
    s_mov_b32 s38, 400000
    s_mov_b64 exec, s[94:95]
    buffer_load_dwordx4 v[208:211], v1, s[48:51], s88 offen offset:0 sc1
    buffer_load_dwordx4 v[212:215], v1, s[48:51], s88 offen offset:64 sc1
    buffer_load_dwordx4 v[216:219], v1, s[48:51], s89 offen offset:128 sc1
    buffer_load_dwordx4 v[220:223], v1, s[48:51], s89 offen offset:192 sc1
    buffer_load_dwordx4 v[224:227], v1, s[48:51], s90 offen sc1
    s_mov_b64 exec, -1
    v_readfirstlane_b32 s16, v204
    v_readfirstlane_b32 s17, v205
L_H_xgo:
    s_waitcnt vmcnt(4)
    v_mfma_f32_16x16x32_bf16 v[4:7], v[208:211], v[16:19], 0
    v_mfma_f32_16x16x32_bf16 v[8:11], v[208:211], v[20:23], 0
    v_mfma_f32_16x16x32_bf16 v[12:15], v[208:211], v[24:27], 0
    v_mfma_f32_16x16x32_bf16 v[196:199], v[208:211], v[28:31], 0
    v_mfma_f32_16x16x32_bf16 v[200:203], v[208:211], v[32:35], 0
    v_mfma_f32_16x16x32_bf16 v[204:207], v[208:211], v[36:39], 0
    v_mfma_f32_16x16x32_bf16 v[240:243], v[208:211], v[40:43], 0
    v_mfma_f32_16x16x32_bf16 v[244:247], v[208:211], v[44:47], 0
    v_mfma_f32_16x16x32_bf16 v[248:251], v[208:211], v[48:51], 0
    s_waitcnt vmcnt(0)
    v_mfma_f32_16x16x32_bf16 v[4:7], v[212:215], v[52:55], v[4:7]
    v_min3_u32 v2, v208, v209, v210
    v_mfma_f32_16x16x32_bf16 v[8:11], v[212:215], v[56:59], v[8:11]
    v_min3_u32 v3, v211, v212, v213
    v_mfma_f32_16x16x32_bf16 v[12:15], v[212:215], v[60:63], v[12:15]
    v_min3_u32 v3, v3, v214, v215
    v_mfma_f32_16x16x32_bf16 v[196:199], v[212:215], v[64:67], v[196:199]
    v_min3_u32 v2, v2, v216, v217
    v_mfma_f32_16x16x32_bf16 v[200:203], v[212:215], v[68:71], v[200:203]
    v_min3_u32 v3, v3, v218, v219
    v_mfma_f32_16x16x32_bf16 v[204:207], v[212:215], v[72:75], v[204:207]
    v_min3_u32 v2, v2, v220, v221
    v_mfma_f32_16x16x32_bf16 v[240:243], v[212:215], v[76:79], v[240:243]
    v_min3_u32 v3, v3, v222, v223
    v_mfma_f32_16x16x32_bf16 v[244:247], v[212:215], v[80:83], v[244:247]
    v_min3_u32 v2, v2, v224, v225
    v_mfma_f32_16x16x32_bf16 v[248:251], v[212:215], v[84:87], v[248:251]
    v_min3_u32 v3, v3, v226, v227
    v_mfma_f32_16x16x32_bf16 v[4:7], v[216:219], v[88:91], v[4:7]
    v_min_u32 v2, v2, v3
    v_mfma_f32_16x16x32_bf16 v[8:11], v[216:219], v[92:95], v[8:11]
    v_cmp_eq_u32 vcc, 0, v2
    v_mfma_f32_16x16x32_bf16 v[12:15], v[216:219], v[96:99], v[12:15]
    v_mfma_f32_16x16x32_bf16 v[196:199], v[216:219], v[100:103], v[196:199]
    v_mfma_f32_16x16x32_bf16 v[200:203], v[216:219], v[104:107], v[200:203]
    v_mfma_f32_16x16x32_bf16 v[204:207], v[216:219], v[108:111], v[204:207]
    v_mfma_f32_16x16x32_bf16 v[240:243], v[216:219], v[112:115], v[240:243]
    v_mfma_f32_16x16x32_bf16 v[244:247], v[216:219], v[116:119], v[244:247]
    v_mfma_f32_16x16x32_bf16 v[248:251], v[216:219], v[120:123], v[248:251]
    s_and_b64 vcc, vcc, s[94:95]
    s_cbranch_scc1 L_H_xretry
L_H_xok:
    s_cmp_ge_u32 s3, 2
    s_cbranch_scc1 L_H_gu4
    v_mfma_f32_16x16x32_bf16 v[4:7], v[224:227], v[160:163], v[4:7]
    v_mfma_f32_16x16x32_bf16 v[8:11], v[224:227], v[164:167], v[8:11]
    v_mfma_f32_16x16x32_bf16 v[12:15], v[224:227], v[168:171], v[12:15]
    v_mfma_f32_16x16x32_bf16 v[196:199], v[224:227], v[172:175], v[196:199]
    v_mfma_f32_16x16x32_bf16 v[200:203], v[224:227], v[176:179], v[200:203]
    v_mfma_f32_16x16x32_bf16 v[204:207], v[224:227], v[180:183], v[204:207]
    v_mfma_f32_16x16x32_bf16 v[240:243], v[224:227], v[184:187], v[240:243]
    v_mfma_f32_16x16x32_bf16 v[244:247], v[224:227], v[188:191], v[244:247]
    v_mfma_f32_16x16x32_bf16 v[248:251], v[224:227], v[192:195], v[248:251]
L_H_gu4:
    v_mfma_f32_16x16x32_bf16 v[4:7], v[220:223], v[124:127], v[4:7]
    v_mfma_f32_16x16x32_bf16 v[8:11], v[220:223], v[128:131], v[8:11]
    v_mfma_f32_16x16x32_bf16 v[12:15], v[220:223], v[132:135], v[12:15]
    v_mfma_f32_16x16x32_bf16 v[196:199], v[220:223], v[136:139], v[196:199]
    v_mfma_f32_16x16x32_bf16 v[200:203], v[220:223], v[140:143], v[200:203]
    v_mfma_f32_16x16x32_bf16 v[204:207], v[220:223], v[144:147], v[204:207]
    s_nop 2
    ds_write_b64 v229, v[4:5] offset:0
    v_mfma_f32_16x16x32_bf16 v[240:243], v[220:223], v[148:151], v[240:243]
    ds_write_b64 v229, v[8:9] offset:512
    v_mfma_f32_16x16x32_bf16 v[244:247], v[220:223], v[152:155], v[244:247]
    ds_write_b64 v229, v[12:13] offset:1024
    v_mfma_f32_16x16x32_bf16 v[248:251], v[220:223], v[156:159], v[248:251]
    ds_write_b64 v229, v[196:197] offset:1536
    ds_write_b64 v229, v[200:201] offset:2048
    ds_write_b64 v229, v[204:205] offset:2560
    s_nop 0
    ds_write_b64 v229, v[240:241] offset:3072
    s_nop 0
    ds_write_b64 v229, v[244:245] offset:3584
    s_nop 0
    ds_write_b64 v229, v[248:249] offset:4096
    s_waitcnt lgkmcnt(0)
    s_barrier
    s_cmp_eq_u32 s3, 3
    s_cbranch_scc1 L_H_fin
    s_cmp_eq_u32 s3, 2
    s_cselect_b32 exec_lo, 0xffff, -1
    s_cselect_b32 exec_hi, 0, -1
    ds_read_b32 v16, v230 offset:0
    ds_read_b32 v17, v231 offset:0
    ds_read_b32 v18, v230 offset:18432
    ds_read_b32 v19, v231 offset:18432
    ds_read_b32 v20, v230 offset:36864
    ds_read_b32 v21, v231 offset:36864
    ds_read_b32 v22, v230 offset:55296
    ds_read_b32 v23, v231 offset:55296
    s_waitcnt lgkmcnt(4)
    v_pk_add_f32 v[16:17], v[16:17], v[18:19]
    s_waitcnt lgkmcnt(0)
    v_pk_add_f32 v[20:21], v[20:21], v[22:23]
    v_pk_add_f32 v[16:17], v[16:17], v[20:21]
    v_cvt_pk_bf16_f32 v18, v16, v17
    v_lshlrev_b32 v16, 16, v18
    v_and_b32 v17, 0xffff0000, v18
    v_mul_f32 v18, 0xbfb8aa3b, v16
    v_exp_f32 v18, v18
    s_nop 0
    v_add_f32 v18, 1.0, v18
    v_rcp_f32 v18, v18
    s_nop 0
    v_mul_f32 v16, v16, v18
    v_cvt_pk_bf16_f32 v16, v16, v16
    v_lshlrev_b32 v16, 16, v16
    v_mul_f32 v16, v16, v17
    v_cvt_pk_bf16_f32 v16, v16, v16
    ds_write_b16 v232, v16
    s_waitcnt lgkmcnt(0)
    s_barrier
    s_endpgm
L_H_xretry:
    s_sub_u32 s38, s38, 1
    s_cbranch_scc1 L_H_xok
    s_mov_b64 exec, s[94:95]
    buffer_load_dwordx4 v[208:211], v1, s[48:51], s88 offen offset:0 sc1
    buffer_load_dwordx4 v[212:215], v1, s[48:51], s88 offen offset:64 sc1
    buffer_load_dwordx4 v[216:219], v1, s[48:51], s89 offen offset:128 sc1
    buffer_load_dwordx4 v[220:223], v1, s[48:51], s89 offen offset:192 sc1
    buffer_load_dwordx4 v[224:227], v1, s[48:51], s90 offen sc1
    s_mov_b64 exec, -1
    s_branch L_H_xgo
L_H_down:
    s_mul_i32 s14, s6, 4608
    s_mul_i32 s15, s8, 1152
    s_add_u32 s14, s14, s15
    s_add_u32 s14, s14, 4227072
    s_barrier
    s_barrier
    ds_read_b128 v[128:131], v233 offset:0
    ds_read_b128 v[132:135], v233 offset:64
    ds_read_b128 v[136:139], v233 offset:128
    s_waitcnt lgkmcnt(2)
    v_mfma_f32_16x16x32_bf16 v[144:147], v[128:131], v[16:19], 0
    v_mfma_f32_16x16x32_bf16 v[148:151], v[128:131], v[20:23], 0
    v_mfma_f32_16x16x32_bf16 v[152:155], v[128:131], v[24:27], 0
    s_waitcnt lgkmcnt(1)
    v_mfma_f32_16x16x32_bf16 v[144:147], v[132:135], v[52:55], v[144:147]
    v_mfma_f32_16x16x32_bf16 v[148:151], v[132:135], v[56:59], v[148:151]
    v_mfma_f32_16x16x32_bf16 v[152:155], v[132:135], v[60:63], v[152:155]
    s_waitcnt lgkmcnt(0)
    v_mfma_f32_16x16x32_bf16 v[144:147], v[136:139], v[88:91], v[144:147]
    v_mfma_f32_16x16x32_bf16 v[148:151], v[136:139], v[92:95], v[148:151]
    v_mfma_f32_16x16x32_bf16 v[152:155], v[136:139], v[96:99], v[152:155]
    v_mfma_f32_16x16x32_bf16 v[156:159], v[128:131], v[28:31], 0
    v_mfma_f32_16x16x32_bf16 v[160:163], v[128:131], v[32:35], 0
    v_mfma_f32_16x16x32_bf16 v[164:167], v[128:131], v[36:39], 0
    v_mfma_f32_16x16x32_bf16 v[156:159], v[132:135], v[64:67], v[156:159]
    v_mfma_f32_16x16x32_bf16 v[160:163], v[132:135], v[68:71], v[160:163]
    s_nop 0
    v_max_u32 v144, 1, v144
    v_max_u32 v145, 1, v145
    v_mfma_f32_16x16x32_bf16 v[164:167], v[132:135], v[72:75], v[164:167]
    buffer_store_dwordx2 v[144:145], v234, s[48:51], s14 offen offset:0 sc1
    v_max_u32 v148, 1, v148
    v_mfma_f32_16x16x32_bf16 v[156:159], v[136:139], v[100:103], v[156:159]
    v_max_u32 v149, 1, v149
    buffer_store_dwordx2 v[148:149], v234, s[48:51], s14 offen offset:128 sc1
    v_mfma_f32_16x16x32_bf16 v[160:163], v[136:139], v[104:107], v[160:163]
    v_max_u32 v152, 1, v152
    v_max_u32 v153, 1, v153
    v_mfma_f32_16x16x32_bf16 v[164:167], v[136:139], v[108:111], v[164:167]
    buffer_store_dwordx2 v[152:153], v234, s[48:51], s14 offen offset:256 sc1
    v_mfma_f32_16x16x32_bf16 v[168:171], v[128:131], v[40:43], 0
    v_mfma_f32_16x16x32_bf16 v[172:175], v[128:131], v[44:47], 0
    v_mfma_f32_16x16x32_bf16 v[176:179], v[128:131], v[48:51], 0
    v_mfma_f32_16x16x32_bf16 v[168:171], v[132:135], v[76:79], v[168:171]
    v_mfma_f32_16x16x32_bf16 v[172:175], v[132:135], v[80:83], v[172:175]
    v_max_u32 v156, 1, v156
    v_max_u32 v157, 1, v157
    v_mfma_f32_16x16x32_bf16 v[176:179], v[132:135], v[84:87], v[176:179]
    buffer_store_dwordx2 v[156:157], v234, s[48:51], s14 offen offset:384 sc1
    v_max_u32 v160, 1, v160
    v_mfma_f32_16x16x32_bf16 v[168:171], v[136:139], v[112:115], v[168:171]
    v_max_u32 v161, 1, v161
    buffer_store_dwordx2 v[160:161], v234, s[48:51], s14 offen offset:512 sc1
    v_mfma_f32_16x16x32_bf16 v[172:175], v[136:139], v[116:119], v[172:175]
    v_max_u32 v164, 1, v164
    v_max_u32 v165, 1, v165
    v_mfma_f32_16x16x32_bf16 v[176:179], v[136:139], v[120:123], v[176:179]
    buffer_store_dwordx2 v[164:165], v234, s[48:51], s14 offen offset:640 sc1
    s_nop 0
    v_max_u32 v168, 1, v168
    v_max_u32 v169, 1, v169
    buffer_store_dwordx2 v[168:169], v234, s[48:51], s14 offen offset:768 sc1
    v_max_u32 v172, 1, v172
    v_max_u32 v173, 1, v173
    buffer_store_dwordx2 v[172:173], v234, s[48:51], s14 offen offset:896 sc1
    v_max_u32 v176, 1, v176
    v_max_u32 v177, 1, v177
    buffer_store_dwordx2 v[176:177], v234, s[48:51], s14 offen offset:1024 sc1
    s_barrier
    s_endpgm
L_H_fin:
    s_barrier
    s_cmp_ge_u32 s6, 36
    s_cbranch_scc1 L_H_end
    s_andn2_b32 s18, 0x7ff, s16
    s_andn2_b32 s19, 0x7ff, s17
    s_lshr_b32 s14, s18, 4
    s_lshr_b32 s15, s19, 4
    s_mul_i32 s20, s14, 2304
    s_mul_i32 s21, s15, 2304
    s_cmp_eq_u32 s14, s15
    s_cselect_b32 s14, 1152, 0
    s_add_u32 s21, s21, s14
    s_mov_b32 s22, 3932160
    s_mov_b32 s24, 0xffff0000
    s_mov_b32 s25, 0xffff0000
    v_mov_b32 v4, s20
    v_mov_b32 v5, s21
    v_cndmask_b32 v6, v4, v5, s[24:25]
    v_add_u32 v6, v6, v236
    v_add_u32 v4, 1152, v236
    v_cndmask_b32 v7, v236, v4, s[24:25]
    s_mov_b32 s23, 4523008
    s_mov_b32 s26, 0
    s_mov_b32 s27, -1
    v_mov_b32 v4, s16
    v_mov_b32 v5, s17
    v_cndmask_b32 v4, v4, v5, s[24:25]
    v_not_b32 v5, v4
    v_ashrrev_i32 v5, 31, v5
    v_or_b32 v5, 0x80000000, v5
    v_xor_b32 v4, v4, v5
    v_and_b32 v4, 0xffff0000, v4
    v_mul_f32 v4, 0xbfb8aa3b, v4
    v_exp_f32 v4, v4
    s_nop 0
    v_add_f32 v4, 1.0, v4
    v_rcp_f32 v10, v4
    s_nop 0
    v_cvt_pk_bf16_f32 v10, v10, v10
    v_lshlrev_b32 v10, 16, v10
    s_mul_i32 s18, s18, 1152
    s_mul_i32 s19, s19, 1152
    v_mov_b32 v4, s18
    v_mov_b32 v5, s19
    v_cndmask_b32 v11, v4, v5, s[24:25]
    v_add_u32 v11, v11, v236
    v_lshrrev_b32 v4, 5, v0
    v_lshl_add_u32 v11, v4, 1, v11
    s_lshl_b32 s14, s6, 7
    s_add_u32 s14, s14, 4227072
    v_add_u32 v57, 36864, v235
    v_add_u32 v58, 73728, v235
    v_add_u32 v59, 110592, v235
    v_add_u32 v60, 147456, v235
    v_add_u32 v61, 184320, v235
    v_add_u32 v62, 221184, v235
    v_add_u32 v63, 258048, v235
    v_mov_b32 v56, v235
    s_barrier
    s_sleep 6
    s_mov_b32 s38, 400000
L_H_ypoll:
    buffer_load_dwordx4 v[16:19], v56, s[48:51], s14 offen sc1
    buffer_load_dwordx4 v[20:23], v57, s[48:51], s14 offen sc1
    buffer_load_dwordx4 v[24:27], v58, s[48:51], s14 offen sc1
    buffer_load_dwordx4 v[28:31], v59, s[48:51], s14 offen sc1
    buffer_load_dwordx4 v[32:35], v60, s[48:51], s14 offen sc1
    buffer_load_dwordx4 v[36:39], v61, s[48:51], s14 offen sc1
    buffer_load_dwordx4 v[40:43], v62, s[48:51], s14 offen sc1
    buffer_load_dwordx4 v[44:47], v63, s[48:51], s14 offen sc1
    buffer_load_dword v8, v6, s[48:51], s22 offen sc1
    buffer_load_dword v9, v7, s[48:51], s23 offen sc1
    s_waitcnt vmcnt(0)
    v_min3_u32 v4, v16, v17, v18
    v_min3_u32 v5, v19, v20, v21
    v_min3_u32 v4, v4, v22, v23
    v_min3_u32 v5, v5, v24, v25
    v_min3_u32 v4, v4, v26, v27
    v_min3_u32 v5, v5, v28, v29
    v_min3_u32 v4, v4, v30, v31
    v_min3_u32 v5, v5, v32, v33
    v_min3_u32 v4, v4, v34, v35
    v_min3_u32 v5, v5, v36, v37
    v_min3_u32 v4, v4, v38, v39
    v_min3_u32 v5, v5, v40, v41
    v_min3_u32 v4, v4, v42, v43
    v_min3_u32 v5, v5, v44, v45
    v_min3_u32 v4, v4, v46, v47
    v_min3_u32 v5, v5, v8, v9
    v_min_u32 v4, v4, v5
    v_cmp_eq_u32 vcc, 0, v4
    s_nop 0
    s_and_b64 exec, exec, vcc
    s_cbranch_scc0 L_H_yok
    s_sub_u32 s38, s38, 1
    s_cbranch_scc0 L_H_ypoll
L_H_yok:
    s_mov_b64 exec, -1
    v_pk_add_f32 v[16:17], v[16:17], v[32:33]
    v_pk_add_f32 v[18:19], v[18:19], v[34:35]
    v_pk_add_f32 v[20:21], v[20:21], v[36:37]
    v_pk_add_f32 v[22:23], v[22:23], v[38:39]
    v_pk_add_f32 v[24:25], v[24:25], v[40:41]
    v_pk_add_f32 v[26:27], v[26:27], v[42:43]
    v_pk_add_f32 v[28:29], v[28:29], v[44:45]
    v_pk_add_f32 v[30:31], v[30:31], v[46:47]
    v_pk_add_f32 v[16:17], v[16:17], v[24:25]
    v_pk_add_f32 v[18:19], v[18:19], v[26:27]
    v_pk_add_f32 v[20:21], v[20:21], v[28:29]
    v_pk_add_f32 v[22:23], v[22:23], v[30:31]
    v_pk_add_f32 v[16:17], v[16:17], v[20:21]
    v_pk_add_f32 v[18:19], v[18:19], v[22:23]
    v_lshlrev_b32 v4, 16, v8
    v_and_b32 v5, 0xffff0000, v8
    v_permlane16_swap_b32 v16, v17
    v_permlane16_swap_b32 v18, v19
    v_add_f32 v16, v16, v17
    v_add_f32 v18, v18, v19
    v_cndmask_b32 v8, v4, v5, s[26:27]
    v_lshlrev_b32 v4, 16, v9
    v_permlane32_swap_b32 v16, v18
    v_add_f32 v16, v16, v18
    v_and_b32 v5, 0xffff0000, v9
    v_cndmask_b32 v9, v4, v5, s[26:27]
    v_add_f32_dpp v16, v16, v16 row_ror:8 row_mask:0xf bank_mask:0xf
    v_cvt_pk_bf16_f32 v16, v16, v16
    v_lshlrev_b32 v16, 16, v16
    v_mul_f32 v16, v16, v10
    v_cvt_pk_bf16_f32 v16, v16, v16
    v_lshlrev_b32 v16, 16, v16
    v_add_f32 v16, v16, v8
    v_cvt_pk_bf16_f32 v16, v16, v16
    v_lshlrev_b32 v16, 16, v16
    v_add_f32 v16, v16, v9
    v_mov_b32 v17, v16
    s_nop 1
    v_permlane32_swap_b32 v16, v17
    s_mov_b64 exec, 0x00ff00ff
    v_cvt_pk_bf16_f32 v16, v16, v17
    buffer_store_dword v16, v11, s[60:63], 0 offen
L_H_end:
    s_endpgm
L_code_end:
L_exit:
    s_endpgm
.section .rodata,"a"
.p2align 6
.amdhsa_kernel sequential_preLN__linear_attn_block__moe_arch_mod__prompt_kernel
  .amdhsa_next_free_vgpr 256
  .amdhsa_next_free_sgpr 102
  .amdhsa_accum_offset 256
  .amdhsa_group_segment_fixed_size 0
  .amdhsa_kernarg_size 88
  .amdhsa_user_sgpr_count 2
  .amdhsa_user_sgpr_kernarg_segment_ptr 1
  .amdhsa_system_sgpr_workgroup_id_x 1
.end_amdhsa_kernel
```
